```python
import torch

def _softmax(x, axis=-1):
    return torch.softmax(x, dim=axis)

def _gelu(x):
    return torch.nn.functional.gelu(x, approximate='tanh')

def _silu(x):
    return torch.nn.functional.silu(x)

def _sigmoid(x):
    return torch.sigmoid(x)

def _layernorm(x, axis=-1, eps=1e-05):
    m = x.mean(dim=axis, keepdim=True)
    v = x.var(dim=axis, keepdim=True, unbiased=False)
    return (x - m) / torch.sqrt(v + eps)

def _scatter_add(tgt, idx, src, axis=0):
    return tgt.clone().index_add_(axis, idx, src)

def _segment_sum(src, seg, n):
    out = torch.zeros((n,) + src.shape[1:], dtype=src.dtype)
    return out.index_add_(0, seg, src)

def _pad(x, pw):
    flat = tuple((v for pair in reversed(pw) for v in pair))
    return torch.nn.functional.pad(x, flat)
kernel_name = 'gather_scatter__molecular_angular_painn__graph'

def setup_inputs():

    _w = lambda a: (lambda t: t.to(torch.bfloat16) if t.is_floating_point() else t)(torch.as_tensor(a))
    N, deg, D = (10000, 16, 128)
    n_rbf = max(16, 4)
    E = N * deg
    cutoff = 5.0
    freqs = (torch.arange(1, n_rbf + 1) * torch.pi / cutoff).to(float)
    return {'sv': _w((lambda *s: torch.randn(*s, dtype=torch.bfloat16) * 0.4)(N, 4, D) * 0.3), 'pos': _w((lambda *s: torch.randn(*s, dtype=torch.bfloat16) * 1.6)(N, 3) * 1.2), 'src': _w((lambda lo, hi, *s: torch.randint(lo, hi, s))(0, N, E).to(torch.int64)), 'dst': _w((lambda lo, hi, *s: torch.randint(lo, hi, s))(0, N, E).to(torch.int64)), 'freqs': _w(freqs), 'w_phi1': _w((lambda *s: torch.randn(*s, dtype=torch.bfloat16) * 3.2)(D, D) / D ** 0.5), 'w_phi2': _w((lambda *s: torch.randn(*s, dtype=torch.bfloat16) * 1.6)(D, 3 * D) / D ** 0.5), 'w_rbf': _w((lambda *s: torch.randn(*s, dtype=torch.bfloat16) * 1.6)(n_rbf, 3 * D) / n_rbf ** 0.5)}

def reference(sv, pos, src, dst, freqs, w_phi1, w_phi2, w_rbf):
    N, _, D = sv.shape
    E = src.shape[0]
    PI, cutoff = (3.141592653589793, 5.0)
    s, v = (sv[:, 0, :].clone(), sv[:, 1:, :].clone())
    r_vec = pos[src] - pos[dst]
    d = torch.sqrt((r_vec * r_vec).sum(-1) + 1e-08)
    r_hat = r_vec / d[:, None]
    rbf = torch.sin(d[:, None] * freqs[None, :]) / d[:, None]
    fcut = 0.5 * (torch.cos(PI * d / cutoff) + 1.0)
    fcut = torch.where(d < cutoff, fcut, 0.0 * d)
    Wf = rbf @ w_rbf * fcut[:, None]
    phi = (_silu(s @ w_phi1) @ w_phi2)[src]
    m = phi * Wf
    m_s, m_vv, m_vr = (m[:, :D].clone(), m[:, D:2 * D].clone(), m[:, 2 * D:].clone())
    ds = _segment_sum(m_s, dst, N)
    dv_e = m_vv[:, None, :] * v[src] + m_vr[:, None, :] * r_hat[:, :, None]
    dv = _segment_sum(dv_e.reshape(E, 3 * D), dst, N).reshape(N, 3, D)
    return sv + torch.concatenate([ds[:, None, :], dv], axis=1)
```

```asm
; @launch grid=(256,1,1) block=(768,1,1) lds=155712
.amdgcn_target "amdgcn-amd-amdhsa--gfx950"
.text
.globl gather_scatter__molecular_angular_painn__graph_kernel
.p2align 8
.type gather_scatter__molecular_angular_painn__graph_kernel,@function
gather_scatter__molecular_angular_painn__graph_kernel:
    s_cmp_ge_u32 s2, 256
    s_cbranch_scc1 K1_END
    s_load_dwordx4 s[4:7], s[0:1], 0
    s_load_dwordx4 s[8:11], s[0:1], 16
    s_load_dwordx4 s[12:15], s[0:1], 32
    s_load_dwordx4 s[16:19], s[0:1], 48
    s_load_dwordx2 s[20:21], s[0:1], 80
    s_load_dwordx2 s[96:97], s[0:1], 72
    s_mov_b32 s91, s2
    s_cmp_lt_u32 s2, 47
    s_cbranch_scc1 K1_BIN
K1_MLP:
    v_lshrrev_b32 v1, 6, v0
    v_and_b32 v2, 63, v0
    s_nop 0
    v_readfirstlane_b32 s3, v1
    v_lshrrev_b32 v3, 4, v2
    v_and_b32 v4, 15, v2
    v_mov_b32 v5, 0
    v_mov_b32 v6, 155648
    ds_write_b32 v6, v5
    s_and_b32 s26, s3, 1
    s_lshl_b32 s26, s26, 2
    v_add_u32 v6, s26, v3
    v_lshrrev_b32 v7, 1, v4
    v_xor_b32 v7, v7, v6
    v_and_b32 v8, 1, v4
    v_lshl_or_b32 v7, v7, 1, v8
    v_lshlrev_b32 v7, 4, v7
    v_lshl_add_u32 v6, v3, 8, v7
    v_mul_u32_u24 v8, 768, v3
    v_add_u32 v7, v8, v7
    s_sub_u32 s24, s91, 47
    s_mul_i32 s24, s24, 48
    s_lshr_b32 s22, s3, 2
    s_and_b32 s23, s3, 3
    s_mov_b32 s30, 10240000
    s_mov_b32 s31, 0x00020000
    s_mov_b32 s34, 32768
    s_mov_b32 s35, 0x00020000
    s_mov_b32 s38, 98304
    s_mov_b32 s39, 0x00020000
    s_waitcnt lgkmcnt(0)
    s_mov_b32 s28, s4
    s_mov_b32 s29, s5
    s_mov_b32 s32, s14
    s_mov_b32 s33, s15
    s_mov_b32 s36, s16
    s_mov_b32 s37, s17
    s_barrier
    s_cmp_ge_u32 s3, 8
    s_cbranch_scc1 K1_LOADER
    s_lshl_b32 s25, s3, 2
    v_add_u32 v5, s25, v3
    v_and_b32 v9, 15, v5
    v_xor_b32 v9, v4, v9
    v_add_u32 v5, s24, v5
    v_lshlrev_b32 v5, 10, v5
    v_lshl_add_u32 v5, v9, 4, v5
    s_lshl_b32 s25, s3, 10
    s_add_u32 s25, s25, 131072
    s_mov_b32 m0, s25
    s_cmp_ge_u32 s3, 4
    buffer_load_dwordx4 v5, s[28:31], 0 offen  lds
    s_cbranch_scc1 K1_S2SKIP
    s_add_u32 s25, s25, 8192
    s_mov_b32 m0, s25
    v_add_u32 v5, 0x8000, v5
    buffer_load_dwordx4 v5, s[28:31], 0 offen  lds
K1_S2SKIP:
    s_add_u32 s25, s3, 0
    s_lshl_b32 s26, s25, 10
    s_mov_b32 m0, s26
    s_nop 0
    buffer_load_dwordx4 v6, s[32:35], s26 offen lds
    s_add_u32 s25, s3, 8
    s_lshl_b32 s26, s25, 10
    s_mov_b32 m0, s26
    s_nop 0
    buffer_load_dwordx4 v6, s[32:35], s26 offen lds
    s_add_u32 s25, s3, 16
    s_lshl_b32 s26, s25, 10
    s_mov_b32 m0, s26
    s_nop 0
    buffer_load_dwordx4 v6, s[32:35], s26 offen lds
    s_add_u32 s25, s3, 24
    s_lshl_b32 s26, s25, 10
    s_mov_b32 m0, s26
    s_nop 0
    buffer_load_dwordx4 v6, s[32:35], s26 offen lds
    s_branch K1_ADDR
K1_LOADER:
    s_sub_u32 s49, s3, 8
    s_add_u32 s25, s49, 0
    s_lshl_b32 s26, s25, 10
    s_add_u32 s26, s26, 32768
    s_mov_b32 m0, s26
    s_mul_i32 s27, s25, 3072
    s_add_u32 s27, s27, 0
    buffer_load_dwordx4 v7, s[36:39], s27 offen lds
    s_add_u32 s25, s49, 4
    s_lshl_b32 s26, s25, 10
    s_add_u32 s26, s26, 32768
    s_mov_b32 m0, s26
    s_mul_i32 s27, s25, 3072
    s_add_u32 s27, s27, 0
    buffer_load_dwordx4 v7, s[36:39], s27 offen lds
    s_add_u32 s25, s49, 8
    s_lshl_b32 s26, s25, 10
    s_add_u32 s26, s26, 32768
    s_mov_b32 m0, s26
    s_mul_i32 s27, s25, 3072
    s_add_u32 s27, s27, 0
    buffer_load_dwordx4 v7, s[36:39], s27 offen lds
    s_add_u32 s25, s49, 12
    s_lshl_b32 s26, s25, 10
    s_add_u32 s26, s26, 32768
    s_mov_b32 m0, s26
    s_mul_i32 s27, s25, 3072
    s_add_u32 s27, s27, 0
    buffer_load_dwordx4 v7, s[36:39], s27 offen lds
    s_add_u32 s25, s49, 16
    s_lshl_b32 s26, s25, 10
    s_add_u32 s26, s26, 32768
    s_mov_b32 m0, s26
    s_mul_i32 s27, s25, 3072
    s_add_u32 s27, s27, 0
    buffer_load_dwordx4 v7, s[36:39], s27 offen lds
    s_add_u32 s25, s49, 20
    s_lshl_b32 s26, s25, 10
    s_add_u32 s26, s26, 32768
    s_mov_b32 m0, s26
    s_mul_i32 s27, s25, 3072
    s_add_u32 s27, s27, 0
    buffer_load_dwordx4 v7, s[36:39], s27 offen lds
    s_add_u32 s25, s49, 24
    s_lshl_b32 s26, s25, 10
    s_add_u32 s26, s26, 32768
    s_mov_b32 m0, s26
    s_mul_i32 s27, s25, 3072
    s_add_u32 s27, s27, 0
    buffer_load_dwordx4 v7, s[36:39], s27 offen lds
    s_add_u32 s25, s49, 28
    s_lshl_b32 s26, s25, 10
    s_add_u32 s26, s26, 32768
    s_mov_b32 m0, s26
    s_mul_i32 s27, s25, 3072
    s_add_u32 s27, s27, 0
    buffer_load_dwordx4 v7, s[36:39], s27 offen lds
    s_add_u32 s25, s49, 0
    s_lshl_b32 s26, s25, 10
    s_add_u32 s26, s26, 65536
    s_mov_b32 m0, s26
    s_mul_i32 s27, s25, 3072
    s_add_u32 s27, s27, 256
    buffer_load_dwordx4 v7, s[36:39], s27 offen lds
    s_add_u32 s25, s49, 4
    s_lshl_b32 s26, s25, 10
    s_add_u32 s26, s26, 65536
    s_mov_b32 m0, s26
    s_mul_i32 s27, s25, 3072
    s_add_u32 s27, s27, 256
    buffer_load_dwordx4 v7, s[36:39], s27 offen lds
    s_add_u32 s25, s49, 8
    s_lshl_b32 s26, s25, 10
    s_add_u32 s26, s26, 65536
    s_mov_b32 m0, s26
    s_mul_i32 s27, s25, 3072
    s_add_u32 s27, s27, 256
    buffer_load_dwordx4 v7, s[36:39], s27 offen lds
    s_add_u32 s25, s49, 12
    s_lshl_b32 s26, s25, 10
    s_add_u32 s26, s26, 65536
    s_mov_b32 m0, s26
    s_mul_i32 s27, s25, 3072
    s_add_u32 s27, s27, 256
    buffer_load_dwordx4 v7, s[36:39], s27 offen lds
    s_add_u32 s25, s49, 16
    s_lshl_b32 s26, s25, 10
    s_add_u32 s26, s26, 65536
    s_mov_b32 m0, s26
    s_mul_i32 s27, s25, 3072
    s_add_u32 s27, s27, 256
    buffer_load_dwordx4 v7, s[36:39], s27 offen lds
    s_add_u32 s25, s49, 20
    s_lshl_b32 s26, s25, 10
    s_add_u32 s26, s26, 65536
    s_mov_b32 m0, s26
    s_mul_i32 s27, s25, 3072
    s_add_u32 s27, s27, 256
    buffer_load_dwordx4 v7, s[36:39], s27 offen lds
    s_add_u32 s25, s49, 24
    s_lshl_b32 s26, s25, 10
    s_add_u32 s26, s26, 65536
    s_mov_b32 m0, s26
    s_mul_i32 s27, s25, 3072
    s_add_u32 s27, s27, 256
    buffer_load_dwordx4 v7, s[36:39], s27 offen lds
    s_add_u32 s25, s49, 28
    s_lshl_b32 s26, s25, 10
    s_add_u32 s26, s26, 65536
    s_mov_b32 m0, s26
    s_mul_i32 s27, s25, 3072
    s_add_u32 s27, s27, 256
    buffer_load_dwordx4 v7, s[36:39], s27 offen lds
    s_add_u32 s25, s49, 0
    s_lshl_b32 s26, s25, 10
    s_add_u32 s26, s26, 98304
    s_mov_b32 m0, s26
    s_mul_i32 s27, s25, 3072
    s_add_u32 s27, s27, 512
    buffer_load_dwordx4 v7, s[36:39], s27 offen lds
    s_add_u32 s25, s49, 4
    s_lshl_b32 s26, s25, 10
    s_add_u32 s26, s26, 98304
    s_mov_b32 m0, s26
    s_mul_i32 s27, s25, 3072
    s_add_u32 s27, s27, 512
    buffer_load_dwordx4 v7, s[36:39], s27 offen lds
    s_add_u32 s25, s49, 8
    s_lshl_b32 s26, s25, 10
    s_add_u32 s26, s26, 98304
    s_mov_b32 m0, s26
    s_mul_i32 s27, s25, 3072
    s_add_u32 s27, s27, 512
    buffer_load_dwordx4 v7, s[36:39], s27 offen lds
    s_add_u32 s25, s49, 12
    s_lshl_b32 s26, s25, 10
    s_add_u32 s26, s26, 98304
    s_mov_b32 m0, s26
    s_mul_i32 s27, s25, 3072
    s_add_u32 s27, s27, 512
    buffer_load_dwordx4 v7, s[36:39], s27 offen lds
    s_add_u32 s25, s49, 16
    s_lshl_b32 s26, s25, 10
    s_add_u32 s26, s26, 98304
    s_mov_b32 m0, s26
    s_mul_i32 s27, s25, 3072
    s_add_u32 s27, s27, 512
    buffer_load_dwordx4 v7, s[36:39], s27 offen lds
    s_add_u32 s25, s49, 20
    s_lshl_b32 s26, s25, 10
    s_add_u32 s26, s26, 98304
    s_mov_b32 m0, s26
    s_mul_i32 s27, s25, 3072
    s_add_u32 s27, s27, 512
    buffer_load_dwordx4 v7, s[36:39], s27 offen lds
    s_add_u32 s25, s49, 24
    s_lshl_b32 s26, s25, 10
    s_add_u32 s26, s26, 98304
    s_mov_b32 m0, s26
    s_mul_i32 s27, s25, 3072
    s_add_u32 s27, s27, 512
    buffer_load_dwordx4 v7, s[36:39], s27 offen lds
    s_add_u32 s25, s49, 28
    s_lshl_b32 s26, s25, 10
    s_add_u32 s26, s26, 98304
    s_mov_b32 m0, s26
    s_mul_i32 s27, s25, 3072
    s_add_u32 s27, s27, 512
    buffer_load_dwordx4 v7, s[36:39], s27 offen lds
K1_ADDR:
    s_mul_i32 s25, s23, 2560000
    s_add_u32 s40, s20, s25
    s_addc_u32 s41, s21, 0
    s_mov_b32 s42, 2560000
    s_mov_b32 s43, 0x00020000
    s_mul_i32 s25, s23, 640000
    s_add_u32 s25, s25, 10240000
    s_add_u32 s44, s20, s25
    s_addc_u32 s45, s21, 0
    s_mov_b32 s46, 640000
    s_mov_b32 s47, 0x00020000
    s_mov_b32 s92, s96
    s_mov_b32 s93, s97
    s_mov_b32 s94, 256
    s_mov_b32 s95, 0x00020000
    s_lshl_b32 s25, s22, 4
    s_add_u32 s25, s25, s24
    s_mov_b32 s48, s25
    v_add_u32 v8, s25, v4
    v_lshlrev_b32 v8, 10, v8
    v_lshl_add_u32 v8, v3, 3, v8
    s_lshl_b32 s26, s23, 6
    s_add_u32 s26, s26, 256
    v_add_u32 v8, s26, v8
    v_lshrrev_b32 v22, 2, v4
    v_lshl_add_u32 v22, v3, 2, v22
    v_and_b32 v23, 7, v22
    v_lshlrev_b32 v22, 8, v22
    v_lshl_add_u32 v22, v23, 5, v22
    v_and_b32 v23, 3, v4
    v_lshl_add_u32 v22, v23, 3, v22
    s_lshl_b32 s25, s23, 6
    v_xor_b32 v24, s25, v22
    v_xor_b32 v25, 32, v24
    v_add_u32 v26, 0x10000, v24
    v_add_u32 v27, 0x10000, v25
    v_lshrrev_b32 v23, 1, v3
    v_xor_b32 v23, v23, v4
    v_lshlrev_b32 v23, 4, v23
    v_and_b32 v28, 1, v3
    v_lshl_add_u32 v23, v28, 3, v23
    v_lshl_add_u32 v23, v4, 8, v23
    v_add_u32 v23, 131072, v23
    v_mov_b32 v28, v23
    v_xor_b32 v29, 32, v23
    v_xor_b32 v30, 64, v23
    v_xor_b32 v31, 96, v23
    v_xor_b32 v32, 128, v23
    v_xor_b32 v33, 160, v23
    v_xor_b32 v34, 192, v23
    v_xor_b32 v35, 224, v23
    v_mov_b32 v38, 0xffff0000
    s_cmp_ge_u32 s3, 8
    s_cbranch_scc1 K1_LOADER2
    s_lshl_b32 s25, s3, 5
    v_xor_b32 v36, s25, v22
    v_xor_b32 v37, s25, v23
    s_waitcnt vmcnt(0)
    v_mov_b32 v39, 155648
    v_mov_b32 v9, 1
    s_mov_b64 exec, 1
    ds_add_u32 v39, v9
    s_mov_b64 exec, -1
K1_SPIN:
    ds_read_b32 v9, v39
    s_waitcnt lgkmcnt(0)
    v_readfirstlane_b32 s25, v9
    s_cmp_lt_u32 s25, 8
    s_cbranch_scc1 K1_SPIN
    ds_read_b64_tr_b16 v[56:57], v36 offset:0
    ds_read_b64_tr_b16 v[58:59], v36 offset:4096
    ds_read_b64_tr_b16 v[60:61], v36 offset:8192
    ds_read_b64_tr_b16 v[62:63], v36 offset:12288
    ds_read_b64_tr_b16 v[64:65], v36 offset:16384
    ds_read_b64_tr_b16 v[66:67], v36 offset:20480
    ds_read_b64_tr_b16 v[68:69], v36 offset:24576
    ds_read_b64_tr_b16 v[70:71], v36 offset:28672
    ds_read_b64 v[72:73], v28 offset:0
    ds_read_b64 v[74:75], v29 offset:0
    ds_read_b64 v[76:77], v30 offset:0
    ds_read_b64 v[78:79], v31 offset:0
    ds_read_b64 v[80:81], v32 offset:0
    ds_read_b64 v[82:83], v33 offset:0
    ds_read_b64 v[84:85], v34 offset:0
    ds_read_b64 v[86:87], v35 offset:0
    ds_read_b64 v[88:89], v28 offset:4096
    ds_read_b64 v[90:91], v29 offset:4096
    ds_read_b64 v[92:93], v30 offset:4096
    ds_read_b64 v[94:95], v31 offset:4096
    ds_read_b64 v[96:97], v32 offset:4096
    ds_read_b64 v[98:99], v33 offset:4096
    ds_read_b64 v[100:101], v34 offset:4096
    ds_read_b64 v[102:103], v35 offset:4096
    ds_read_b64 v[104:105], v28 offset:8192
    ds_read_b64 v[106:107], v29 offset:8192
    ds_read_b64 v[108:109], v30 offset:8192
    ds_read_b64 v[110:111], v31 offset:8192
    ds_read_b64 v[112:113], v32 offset:8192
    ds_read_b64 v[114:115], v33 offset:8192
    ds_read_b64 v[116:117], v34 offset:8192
    ds_read_b64 v[118:119], v35 offset:8192
    buffer_load_dwordx2 v[10:11], v8, s[28:31], 0 offen offset:0
    buffer_load_dwordx2 v[12:13], v8, s[28:31], 0 offen offset:32
    buffer_load_dwordx2 v[14:15], v8, s[28:31], 0 offen offset:256
    buffer_load_dwordx2 v[16:17], v8, s[28:31], 0 offen offset:288
    buffer_load_dwordx2 v[18:19], v8, s[28:31], 0 offen offset:512
    buffer_load_dwordx2 v[20:21], v8, s[28:31], 0 offen offset:544
    v_mov_b32 v40, 0
    v_mov_b32 v41, 0
    v_mov_b32 v42, 0
    v_mov_b32 v43, 0
    v_mov_b32 v44, 0
    v_mov_b32 v45, 0
    v_mov_b32 v46, 0
    v_mov_b32 v47, 0
    v_mov_b32 v48, 0
    v_mov_b32 v49, 0
    v_mov_b32 v50, 0
    v_mov_b32 v51, 0
    s_waitcnt lgkmcnt(0)
    v_mfma_f32_16x16x32_bf16 v[40:43], v[56:59], v[72:75], v[40:43]
    v_mfma_f32_16x16x32_bf16 v[44:47], v[56:59], v[88:91], v[44:47]
    v_mfma_f32_16x16x32_bf16 v[48:51], v[56:59], v[104:107], v[48:51]
    v_mfma_f32_16x16x32_bf16 v[40:43], v[60:63], v[76:79], v[40:43]
    v_mfma_f32_16x16x32_bf16 v[44:47], v[60:63], v[92:95], v[44:47]
    v_mfma_f32_16x16x32_bf16 v[48:51], v[60:63], v[108:111], v[48:51]
    v_mfma_f32_16x16x32_bf16 v[40:43], v[64:67], v[80:83], v[40:43]
    v_mfma_f32_16x16x32_bf16 v[44:47], v[64:67], v[96:99], v[44:47]
    v_mfma_f32_16x16x32_bf16 v[48:51], v[64:67], v[112:115], v[48:51]
    v_mfma_f32_16x16x32_bf16 v[40:43], v[68:71], v[84:87], v[40:43]
    v_mfma_f32_16x16x32_bf16 v[44:47], v[68:71], v[100:103], v[44:47]
    v_mfma_f32_16x16x32_bf16 v[48:51], v[68:71], v[116:119], v[48:51]
    s_nop 7
    v_cvt_pk_bf16_f32 v56, v40, v41
    v_cvt_pk_bf16_f32 v57, v42, v43
    v_cvt_pk_bf16_f32 v58, v44, v45
    v_cvt_pk_bf16_f32 v59, v46, v47
    v_cvt_pk_bf16_f32 v60, v48, v49
    v_cvt_pk_bf16_f32 v61, v50, v51
    v_lshlrev_b32 v40, 16, v56
    v_and_b32 v41, v38, v56
    v_lshlrev_b32 v42, 16, v57
    v_and_b32 v43, v38, v57
    v_lshlrev_b32 v44, 16, v58
    v_and_b32 v45, v38, v58
    v_lshlrev_b32 v46, 16, v59
    v_and_b32 v47, v38, v59
    v_lshlrev_b32 v48, 16, v60
    v_and_b32 v49, v38, v60
    v_lshlrev_b32 v50, 16, v61
    v_and_b32 v51, v38, v61
    v_mul_f32 v56, 0xbfb8aa3b, v40
    v_mul_f32 v57, 0xbfb8aa3b, v41
    v_mul_f32 v58, 0xbfb8aa3b, v42
    v_mul_f32 v59, 0xbfb8aa3b, v43
    v_mul_f32 v60, 0xbfb8aa3b, v44
    v_mul_f32 v61, 0xbfb8aa3b, v45
    v_mul_f32 v62, 0xbfb8aa3b, v46
    v_mul_f32 v63, 0xbfb8aa3b, v47
    v_mul_f32 v64, 0xbfb8aa3b, v48
    v_mul_f32 v65, 0xbfb8aa3b, v49
    v_mul_f32 v66, 0xbfb8aa3b, v50
    v_mul_f32 v67, 0xbfb8aa3b, v51
    v_exp_f32 v56, v56
    v_exp_f32 v57, v57
    v_exp_f32 v58, v58
    v_exp_f32 v59, v59
    v_exp_f32 v60, v60
    v_exp_f32 v61, v61
    v_exp_f32 v62, v62
    v_exp_f32 v63, v63
    v_exp_f32 v64, v64
    v_exp_f32 v65, v65
    v_exp_f32 v66, v66
    v_exp_f32 v67, v67
    s_nop 0
    v_add_f32 v56, 1.0, v56
    v_add_f32 v57, 1.0, v57
    v_add_f32 v58, 1.0, v58
    v_add_f32 v59, 1.0, v59
    v_add_f32 v60, 1.0, v60
    v_add_f32 v61, 1.0, v61
    v_add_f32 v62, 1.0, v62
    v_add_f32 v63, 1.0, v63
    v_add_f32 v64, 1.0, v64
    v_add_f32 v65, 1.0, v65
    v_add_f32 v66, 1.0, v66
    v_add_f32 v67, 1.0, v67
    v_rcp_f32 v56, v56
    v_rcp_f32 v57, v57
    v_rcp_f32 v58, v58
    v_rcp_f32 v59, v59
    v_rcp_f32 v60, v60
    v_rcp_f32 v61, v61
    v_rcp_f32 v62, v62
    v_rcp_f32 v63, v63
    v_rcp_f32 v64, v64
    v_rcp_f32 v65, v65
    v_rcp_f32 v66, v66
    v_rcp_f32 v67, v67
    s_nop 0
    v_mul_f32 v56, v40, v56
    v_mul_f32 v57, v41, v57
    v_mul_f32 v58, v42, v58
    v_mul_f32 v59, v43, v59
    v_mul_f32 v60, v44, v60
    v_mul_f32 v61, v45, v61
    v_mul_f32 v62, v46, v62
    v_mul_f32 v63, v47, v63
    v_mul_f32 v64, v48, v64
    v_mul_f32 v65, v49, v65
    v_mul_f32 v66, v50, v66
    v_mul_f32 v67, v51, v67
    v_cvt_pk_bf16_f32 v40, v56, v57
    v_cvt_pk_bf16_f32 v41, v58, v59
    v_cvt_pk_bf16_f32 v42, v60, v61
    v_cvt_pk_bf16_f32 v43, v62, v63
    v_cvt_pk_bf16_f32 v44, v64, v65
    v_cvt_pk_bf16_f32 v45, v66, v67
    ds_write_b64 v37, v[40:41] offset:12288
    ds_write_b64 v37, v[42:43] offset:16384
    ds_write_b64 v37, v[44:45] offset:20480
    s_waitcnt vmcnt(6) lgkmcnt(0)
    s_branch K1_B2
K1_LOADER2:
    buffer_load_dwordx2 v[10:11], v8, s[28:31], 0 offen offset:0
    buffer_load_dwordx2 v[12:13], v8, s[28:31], 0 offen offset:32
    buffer_load_dwordx2 v[14:15], v8, s[28:31], 0 offen offset:256
    buffer_load_dwordx2 v[16:17], v8, s[28:31], 0 offen offset:288
    buffer_load_dwordx2 v[18:19], v8, s[28:31], 0 offen offset:512
    buffer_load_dwordx2 v[20:21], v8, s[28:31], 0 offen offset:544
    s_waitcnt vmcnt(6)
K1_B2:
    s_lshl_b32 s25, s22, 12
    v_add_u32 v28, s25, v28
    v_add_u32 v29, s25, v29
    v_add_u32 v30, s25, v30
    v_add_u32 v31, s25, v31
    v_add_u32 v32, s25, v32
    v_add_u32 v33, s25, v33
    v_add_u32 v34, s25, v34
    v_add_u32 v35, s25, v35
    s_barrier
    s_cmp_lg_u32 s3, 0
    s_cbranch_scc1 K1_NLM
    v_mov_b32 v165, 0
    buffer_load_dword v166, v165, s[92:95], 0 offen sc1
K1_NLM:
    ds_read_b64 v[40:41], v28 offset:12288
    ds_read_b64 v[42:43], v29 offset:12288
    ds_read_b64 v[44:45], v30 offset:12288
    ds_read_b64 v[46:47], v31 offset:12288
    ds_read_b64 v[48:49], v32 offset:12288
    ds_read_b64 v[50:51], v33 offset:12288
    ds_read_b64 v[52:53], v34 offset:12288
    ds_read_b64 v[54:55], v35 offset:12288
    s_lshl_b32 s25, s3, 11
    v_and_b32 v9, 7, v4
    v_lshlrev_b32 v28, 1, v3
    v_xor_b32 v28, v28, v9
    v_lshlrev_b32 v28, 4, v28
    v_lshl_add_u32 v28, v4, 7, v28
    v_add_u32 v28, s25, v28
    v_xor_b32 v29, 16, v28
    v_lshrrev_b32 v30, 3, v2
    v_and_b32 v31, 7, v2
    v_xor_b32 v33, v31, v30
    v_lshlrev_b32 v33, 4, v33
    v_lshl_add_u32 v33, v30, 7, v33
    v_add_u32 v33, s25, v33
    s_lshl_b32 s26, s48, 8
    v_lshlrev_b32 v34, 8, v30
    v_lshl_add_u32 v34, v31, 4, v34
    v_add_u32 v34, s26, v34
    s_lshl_b32 s25, s3, 10
    s_add_u32 s25, s25, 131072
    v_lshlrev_b32 v32, 6, v4
    v_lshl_add_u32 v32, v3, 3, v32
    v_add_u32 v32, s25, v32
    v_lshlrev_b32 v39, 4, v2
    v_add_u32 v37, s25, v39
    s_lshl_b32 s27, s48, 6
    v_add_u32 v39, s27, v39
    ds_read_b64_tr_b16 v[56:57], v24 offset:32768
    ds_read_b64_tr_b16 v[58:59], v24 offset:36864
    ds_read_b64_tr_b16 v[60:61], v24 offset:40960
    ds_read_b64_tr_b16 v[62:63], v24 offset:45056
    ds_read_b64_tr_b16 v[64:65], v24 offset:49152
    ds_read_b64_tr_b16 v[66:67], v24 offset:53248
    ds_read_b64_tr_b16 v[68:69], v24 offset:57344
    ds_read_b64_tr_b16 v[70:71], v24 offset:61440
    s_waitcnt lgkmcnt(8)
    v_mov_b32 v96, 0
    v_mov_b32 v97, 0
    v_mov_b32 v98, 0
    v_mov_b32 v99, 0
    v_mov_b32 v100, 0
    v_mov_b32 v101, 0
    v_mov_b32 v102, 0
    v_mov_b32 v103, 0
    v_mov_b32 v104, 0
    v_mov_b32 v105, 0
    v_mov_b32 v106, 0
    v_mov_b32 v107, 0
    s_waitcnt lgkmcnt(7)
    ds_read_b64_tr_b16 v[72:73], v26 offset:0
    ds_read_b64_tr_b16 v[74:75], v26 offset:4096
    ds_read_b64_tr_b16 v[76:77], v26 offset:8192
    ds_read_b64_tr_b16 v[78:79], v26 offset:12288
    ds_read_b64_tr_b16 v[80:81], v26 offset:16384
    ds_read_b64_tr_b16 v[82:83], v26 offset:20480
    ds_read_b64_tr_b16 v[84:85], v26 offset:24576
    ds_read_b64_tr_b16 v[86:87], v26 offset:28672
    s_waitcnt lgkmcnt(8)
    v_mfma_f32_16x16x32_bf16 v[96:99], v[56:59], v[40:43], v[96:99]
    v_mfma_f32_16x16x32_bf16 v[96:99], v[60:63], v[44:47], v[96:99]
    v_mfma_f32_16x16x32_bf16 v[96:99], v[64:67], v[48:51], v[96:99]
    v_mfma_f32_16x16x32_bf16 v[96:99], v[68:71], v[52:55], v[96:99]
    s_waitcnt lgkmcnt(7)
    ds_read_b64_tr_b16 v[120:121], v26 offset:32768
    ds_read_b64_tr_b16 v[122:123], v26 offset:36864
    ds_read_b64_tr_b16 v[124:125], v26 offset:40960
    ds_read_b64_tr_b16 v[126:127], v26 offset:45056
    ds_read_b64_tr_b16 v[128:129], v26 offset:49152
    ds_read_b64_tr_b16 v[130:131], v26 offset:53248
    ds_read_b64_tr_b16 v[132:133], v26 offset:57344
    ds_read_b64_tr_b16 v[134:135], v26 offset:61440
    s_waitcnt lgkmcnt(8)
    v_mfma_f32_16x16x32_bf16 v[100:103], v[72:75], v[40:43], v[100:103]
    v_mfma_f32_16x16x32_bf16 v[100:103], v[76:79], v[44:47], v[100:103]
    v_mfma_f32_16x16x32_bf16 v[100:103], v[80:83], v[48:51], v[100:103]
    v_mfma_f32_16x16x32_bf16 v[100:103], v[84:87], v[52:55], v[100:103]
    s_waitcnt lgkmcnt(7)
    ds_read_b64_tr_b16 v[56:57], v25 offset:32768
    ds_read_b64_tr_b16 v[58:59], v25 offset:36864
    ds_read_b64_tr_b16 v[60:61], v25 offset:40960
    ds_read_b64_tr_b16 v[62:63], v25 offset:45056
    ds_read_b64_tr_b16 v[64:65], v25 offset:49152
    ds_read_b64_tr_b16 v[66:67], v25 offset:53248
    ds_read_b64_tr_b16 v[68:69], v25 offset:57344
    ds_read_b64_tr_b16 v[70:71], v25 offset:61440
    s_waitcnt lgkmcnt(8)
    v_mfma_f32_16x16x32_bf16 v[104:107], v[120:123], v[40:43], v[104:107]
    v_mfma_f32_16x16x32_bf16 v[104:107], v[124:127], v[44:47], v[104:107]
    v_mfma_f32_16x16x32_bf16 v[104:107], v[128:131], v[48:51], v[104:107]
    v_mfma_f32_16x16x32_bf16 v[104:107], v[132:135], v[52:55], v[104:107]
    s_waitcnt vmcnt(0)
    s_nop 7
    v_cvt_pk_bf16_f32 v88, v96, v97
    v_cvt_pk_bf16_f32 v89, v98, v99
    v_cvt_pk_bf16_f32 v83, v104, v105
    v_cvt_pk_bf16_f32 v87, v106, v107
    v_cvt_pk_bf16_f32 v108, v100, v101
    v_cvt_pk_bf16_f32 v109, v102, v103
    v_lshlrev_b32 v90, 16, v108
    v_and_b32 v91, v38, v108
    v_lshlrev_b32 v92, 16, v109
    v_and_b32 v93, v38, v109
    v_lshlrev_b32 v108, 16, v10
    v_and_b32 v109, v38, v10
    v_lshlrev_b32 v110, 16, v11
    v_and_b32 v111, v38, v11
    v_pk_mul_f32 v[108:109], v[108:109], v[90:91]
    v_pk_mul_f32 v[110:111], v[110:111], v[92:93]
    v_cvt_pk_bf16_f32 v80, v108, v109
    v_cvt_pk_bf16_f32 v84, v110, v111
    v_lshlrev_b32 v108, 16, v14
    v_and_b32 v109, v38, v14
    v_lshlrev_b32 v110, 16, v15
    v_and_b32 v111, v38, v15
    v_pk_mul_f32 v[108:109], v[108:109], v[90:91]
    v_pk_mul_f32 v[110:111], v[110:111], v[92:93]
    v_cvt_pk_bf16_f32 v81, v108, v109
    v_cvt_pk_bf16_f32 v85, v110, v111
    v_lshlrev_b32 v108, 16, v18
    v_and_b32 v109, v38, v18
    v_lshlrev_b32 v110, 16, v19
    v_and_b32 v111, v38, v19
    v_pk_mul_f32 v[108:109], v[108:109], v[90:91]
    v_pk_mul_f32 v[110:111], v[110:111], v[92:93]
    v_cvt_pk_bf16_f32 v82, v108, v109
    v_cvt_pk_bf16_f32 v86, v110, v111
    ds_write_b128 v28, v[80:83]
    ds_write_b128 v29, v[84:87]
    ds_write_b64 v32, v[88:89] offset:0
    ds_read_b128 v[112:115], v33
    ds_read_b128 v[116:119], v33 offset:1024
    s_waitcnt lgkmcnt(1)
    buffer_store_dwordx4 v[112:115], v34, s[40:43], 0 offen offset:0 sc1
    s_waitcnt lgkmcnt(0)
    buffer_store_dwordx4 v[116:119], v34, s[40:43], 0 offen offset:2048 sc1
    v_mov_b32 v96, 0
    v_mov_b32 v97, 0
    v_mov_b32 v98, 0
    v_mov_b32 v99, 0
    v_mov_b32 v100, 0
    v_mov_b32 v101, 0
    v_mov_b32 v102, 0
    v_mov_b32 v103, 0
    v_mov_b32 v104, 0
    v_mov_b32 v105, 0
    v_mov_b32 v106, 0
    v_mov_b32 v107, 0
    s_waitcnt lgkmcnt(7)
    ds_read_b64_tr_b16 v[72:73], v27 offset:0
    ds_read_b64_tr_b16 v[74:75], v27 offset:4096
    ds_read_b64_tr_b16 v[76:77], v27 offset:8192
    ds_read_b64_tr_b16 v[78:79], v27 offset:12288
    ds_read_b64_tr_b16 v[80:81], v27 offset:16384
    ds_read_b64_tr_b16 v[82:83], v27 offset:20480
    ds_read_b64_tr_b16 v[84:85], v27 offset:24576
    ds_read_b64_tr_b16 v[86:87], v27 offset:28672
    s_waitcnt lgkmcnt(8)
    v_mfma_f32_16x16x32_bf16 v[96:99], v[56:59], v[40:43], v[96:99]
    v_mfma_f32_16x16x32_bf16 v[96:99], v[60:63], v[44:47], v[96:99]
    v_mfma_f32_16x16x32_bf16 v[96:99], v[64:67], v[48:51], v[96:99]
    v_mfma_f32_16x16x32_bf16 v[96:99], v[68:71], v[52:55], v[96:99]
    s_waitcnt lgkmcnt(7)
    ds_read_b64_tr_b16 v[120:121], v27 offset:32768
    ds_read_b64_tr_b16 v[122:123], v27 offset:36864
    ds_read_b64_tr_b16 v[124:125], v27 offset:40960
    ds_read_b64_tr_b16 v[126:127], v27 offset:45056
    ds_read_b64_tr_b16 v[128:129], v27 offset:49152
    ds_read_b64_tr_b16 v[130:131], v27 offset:53248
    ds_read_b64_tr_b16 v[132:133], v27 offset:57344
    ds_read_b64_tr_b16 v[134:135], v27 offset:61440
    s_waitcnt lgkmcnt(8)
    v_mfma_f32_16x16x32_bf16 v[100:103], v[72:75], v[40:43], v[100:103]
    v_mfma_f32_16x16x32_bf16 v[100:103], v[76:79], v[44:47], v[100:103]
    v_mfma_f32_16x16x32_bf16 v[100:103], v[80:83], v[48:51], v[100:103]
    v_mfma_f32_16x16x32_bf16 v[100:103], v[84:87], v[52:55], v[100:103]
    s_waitcnt lgkmcnt(0)
    v_mfma_f32_16x16x32_bf16 v[104:107], v[120:123], v[40:43], v[104:107]
    v_mfma_f32_16x16x32_bf16 v[104:107], v[124:127], v[44:47], v[104:107]
    v_mfma_f32_16x16x32_bf16 v[104:107], v[128:131], v[48:51], v[104:107]
    v_mfma_f32_16x16x32_bf16 v[104:107], v[132:135], v[52:55], v[104:107]
    s_nop 7
    v_cvt_pk_bf16_f32 v88, v96, v97
    v_cvt_pk_bf16_f32 v89, v98, v99
    v_cvt_pk_bf16_f32 v83, v104, v105
    v_cvt_pk_bf16_f32 v87, v106, v107
    v_cvt_pk_bf16_f32 v108, v100, v101
    v_cvt_pk_bf16_f32 v109, v102, v103
    v_lshlrev_b32 v90, 16, v108
    v_and_b32 v91, v38, v108
    v_lshlrev_b32 v92, 16, v109
    v_and_b32 v93, v38, v109
    v_lshlrev_b32 v108, 16, v12
    v_and_b32 v109, v38, v12
    v_lshlrev_b32 v110, 16, v13
    v_and_b32 v111, v38, v13
    v_pk_mul_f32 v[108:109], v[108:109], v[90:91]
    v_pk_mul_f32 v[110:111], v[110:111], v[92:93]
    v_cvt_pk_bf16_f32 v80, v108, v109
    v_cvt_pk_bf16_f32 v84, v110, v111
    v_lshlrev_b32 v108, 16, v16
    v_and_b32 v109, v38, v16
    v_lshlrev_b32 v110, 16, v17
    v_and_b32 v111, v38, v17
    v_pk_mul_f32 v[108:109], v[108:109], v[90:91]
    v_pk_mul_f32 v[110:111], v[110:111], v[92:93]
    v_cvt_pk_bf16_f32 v81, v108, v109
    v_cvt_pk_bf16_f32 v85, v110, v111
    v_lshlrev_b32 v108, 16, v20
    v_and_b32 v109, v38, v20
    v_lshlrev_b32 v110, 16, v21
    v_and_b32 v111, v38, v21
    v_pk_mul_f32 v[108:109], v[108:109], v[90:91]
    v_pk_mul_f32 v[110:111], v[110:111], v[92:93]
    v_cvt_pk_bf16_f32 v82, v108, v109
    v_cvt_pk_bf16_f32 v86, v110, v111
    ds_write_b128 v28, v[80:83]
    ds_write_b128 v29, v[84:87]
    ds_write_b64 v32, v[88:89] offset:32
    ds_read_b128 v[40:43], v33
    ds_read_b128 v[44:47], v33 offset:1024
    ds_read_b128 v[48:51], v37
    s_waitcnt lgkmcnt(2)
    buffer_store_dwordx4 v[40:43], v34, s[40:43], 0 offen offset:128 sc1
    s_waitcnt lgkmcnt(1)
    buffer_store_dwordx4 v[44:47], v34, s[40:43], 0 offen offset:2176 sc1
    s_waitcnt lgkmcnt(0)
    buffer_store_dwordx4 v[48:51], v39, s[44:47], 0 offen sc1
    s_mov_b32 s101, 1
    s_waitcnt lgkmcnt(0)
    s_barrier
    s_cmp_lg_u32 s3, 0
    s_cbranch_scc1 K2_START
    s_waitcnt vmcnt(5)
    s_mov_b32 s68, 0x10000
K1_NLOOPM:
    v_readfirstlane_b32 s100, v166
    s_cmp_lg_u32 s100, 0
    s_cbranch_scc1 K1_NOKM
    v_mov_b32 v165, 0
    buffer_load_dword v166, v165, s[92:95], 0 offen sc1
    s_waitcnt vmcnt(0)
    s_sub_u32 s68, s68, 1
    s_cmp_lg_u32 s68, 0
    s_cbranch_scc1 K1_NLOOPM
K1_NOKM:
K2_START:
    s_setprio 3
    s_load_dwordx2 s[4:5], s[0:1], 0
    s_load_dwordx2 s[8:9], s[0:1], 64
    s_load_dwordx2 s[10:11], s[0:1], 80
    v_mbcnt_lo_u32_b32 v166, -1, 0
    v_mbcnt_hi_u32_b32 v166, -1, v166
    s_and_b32 s12, s2, 7
    s_lshr_b32 s13, s12, 1
    s_lshr_b32 s14, s2, 3
    s_lshl_b32 s14, s14, 1
    s_and_b32 s12, s12, 1
    s_add_u32 s14, s14, s12
    s_mul_i32 s14, s14, 12
    s_add_u32 s14, s14, s3
    s_mul_i32 s15, s14, 853362
    s_add_u32 s16, s15, 65000
    s_lshr_b32 s15, s16, 16
    s_add_u32 s16, s16, 853362
    s_lshr_b32 s16, s16, 16
    s_min_u32 s16, s16, 10000
    s_sub_u32 s16, s16, s15
    v_mul_u32_u24 v6, 3072, v166
    s_lshl_b32 s17, s14, 2
    s_waitcnt lgkmcnt(0)
    s_add_u32 s20, s10, 0xca0000
    s_addc_u32 s21, s11, 0
    s_mov_b32 s22, 144384
    s_mov_b32 s23, 0x00020000
    s_add_u32 s24, s10, 0xd00000
    s_addc_u32 s25, s11, 0
    s_mov_b32 s26, 3080192
    s_mov_b32 s27, 0x00020000
    s_add_u32 s28, s10, 0xc80000
    s_addc_u32 s29, s11, 0
    s_mov_b32 s30, 65536
    s_mov_b32 s31, 0x00020000
    s_add_u32 s40, s10, 0xc90000
    s_addc_u32 s41, s11, 0
    s_mov_b32 s42, 12288
    s_mov_b32 s43, 0x00020000
    s_mov_b32 s32, s4
    s_mov_b32 s33, s5
    s_mov_b32 s34, 10240000
    s_mov_b32 s35, 0x00020000
    s_mov_b32 s36, s8
    s_mov_b32 s37, s9
    s_mov_b32 s38, 10240000
    s_mov_b32 s39, 0x00020000
    s_mul_i32 s17, s13, 2560000
    s_add_u32 s44, s10, s17
    s_addc_u32 s45, s11, 0
    s_or_b32 s45, s45, 0x100000
    s_mov_b32 s46, 160000
    s_mov_b32 s47, 0x00020000
    s_mul_i32 s17, s13, 640000
    s_add_u32 s17, s17, 10240000
    s_add_u32 s48, s10, s17
    s_addc_u32 s49, s11, 0
    s_or_b32 s49, s49, 0x40000
    s_mov_b32 s50, 160000
    s_mov_b32 s51, 0x00020000
    v_and_b32 v0, 15, v166
    v_lshrrev_b32 v167, 4, v166
    v_sub_u32 v1, 15, v0
    v_lshl_or_b32 v1, v1, 16, v1
    v_lshlrev_b32 v2, 3, v167
    v_lshlrev_b32 v8, 2, v166
    v_mov_b32 v9, 0
    ds_write_b32 v8, v9 offset:17408
    ds_write_b32 v8, v9 offset:18176
    v_mov_b32 v22, 0
    v_mov_b32 v23, 0
    v_mov_b32 v24, 0
    v_mov_b32 v25, 0
    v_mov_b32 v26, 0
    v_mov_b32 v27, 0
    v_mov_b32 v28, 0
    v_mov_b32 v29, 0
    v_mov_b32 v30, 0
    v_mov_b32 v31, 0
    v_mov_b32 v32, 0
    v_mov_b32 v33, 0
    v_mov_b32 v34, 0
    v_mov_b32 v35, 0
    v_mov_b32 v36, 0
    v_mov_b32 v37, 0
    v_mov_b32 v38, 0
    v_mov_b32 v39, 0
    v_mov_b32 v40, 0
    v_mov_b32 v41, 0
    v_mov_b32 v42, 0
    v_mov_b32 v43, 0
    v_mov_b32 v44, 0
    v_mov_b32 v45, 0
    v_mov_b32 v46, 0
    v_mov_b32 v47, 0
    v_mov_b32 v48, 0
    v_mov_b32 v49, 0
    v_mov_b32 v50, 0
    v_mov_b32 v51, 0
    v_mov_b32 v52, 0
    v_mov_b32 v53, 0
    v_mov_b32 v118, 0
    v_mov_b32 v119, 0
    v_mov_b32 v120, 0
    v_mov_b32 v121, 0
    v_mov_b32 v122, 0
    v_mov_b32 v123, 0
    v_mov_b32 v124, 0
    v_mov_b32 v125, 0
    v_mov_b32 v126, 0
    v_mov_b32 v127, 0
    v_mov_b32 v128, 0
    v_mov_b32 v129, 0
    v_mov_b32 v130, 0
    v_mov_b32 v131, 0
    v_mov_b32 v132, 0
    v_mov_b32 v133, 0
    v_mov_b32 v134, 0
    v_mov_b32 v135, 0
    v_mov_b32 v136, 0
    v_mov_b32 v137, 0
    v_mov_b32 v138, 0
    v_mov_b32 v139, 0
    v_mov_b32 v140, 0
    v_mov_b32 v141, 0
    v_mov_b32 v142, 0
    v_mov_b32 v143, 0
    v_mov_b32 v144, 0
    v_mov_b32 v145, 0
    v_mov_b32 v146, 0
    v_mov_b32 v147, 0
    v_mov_b32 v148, 0
    v_mov_b32 v149, 0
    v_mov_b32 v150, 0
    v_mov_b32 v151, 0
    v_mov_b32 v152, 0
    v_mov_b32 v153, 0
    s_mul_i32 s18, s3, 5120
    s_add_u32 s18, s18, 18432
    s_mov_b32 s52, 0
    s_mov_b32 s60, 0
    s_mov_b32 s97, s3
    s_cmp_lg_u32 s3, 0
    s_cbranch_scc1 K2_POLLA_DONE
    s_mov_b32 s59, 0x8000
K2_POLLA:
    s_mov_b64 exec, 0xfff
    v_mbcnt_lo_u32_b32 v167, -1, 0
    v_mbcnt_hi_u32_b32 v167, -1, v167
    v_lshlrev_b32 v167, 4, v167
    s_add_u32 s64, s10, 0xcf0000
    s_addc_u32 s65, s11, 0
    s_mov_b32 s66, 16384
    s_mov_b32 s67, 0x00020000
    s_and_b32 s62, s2, 7
    s_lshl_b32 s62, s62, 11
    buffer_load_dwordx4 v[94:97], v167, s[64:67], s62 offen offset:0 sc1
    s_mov_b64 exec, -1
    s_waitcnt vmcnt(0)
    v_cmp_eq_u32 s[56:57], s100, v94
    v_cmp_eq_u32 s[62:63], s100, v95
    v_cmp_eq_u32 vcc, s100, v96
    s_and_b64 s[56:57], s[56:57], s[62:63]
    s_and_b64 s[56:57], s[56:57], vcc
    v_cmp_eq_u32 vcc, s100, v97
    s_and_b32 s56, s56, 0xfff
    s_and_b32 s62, vcc_lo, 0x7ff
    s_lshl_b32 s62, s62, 12
    s_or_b32 s56, s56, s62
    s_cmp_eq_u32 s56, 0x7fffff
    s_cbranch_scc1 K2_POLLA_DONE
    s_sleep 2
    s_sub_u32 s59, s59, 1
    s_cmp_lg_u32 s59, 0
    s_cbranch_scc1 K2_POLLA
K2_POLLA_DONE:
    s_waitcnt vmcnt(0) lgkmcnt(0)
    s_barrier
    v_mbcnt_lo_u32_b32 v166, -1, 0
    v_mbcnt_hi_u32_b32 v166, -1, v166
    s_cmp_eq_u32 s3, 0
    s_cselect_b32 s62, s101, 0
    s_cmp_eq_u32 s62, 0
    s_cbranch_scc1 K2_NOPUB2
    s_add_u32 s64, s10, 0xcf0000
    s_addc_u32 s65, s11, 0
    s_mov_b32 s66, 16384
    s_mov_b32 s67, 0x00020000
    v_lshlrev_b32 v94, 11, v166
    s_lshl_b32 s68, s91, 2
    v_mov_b32 v95, s100
    s_mov_b64 exec, 0xff
    buffer_store_dword v95, v94, s[64:67], s68 offen sc1
    s_mov_b64 exec, -1
K2_NOPUB2:
    v_lshlrev_b32 v8, 4, v166
    s_lshl_b32 s17, s3, 10
    s_add_u32 s17, s17, 47104
    buffer_load_dwordx4 v[54:57], v8, s[28:31], s17 offen sc1
    s_cmp_lt_u32 s3, 5
    s_cbranch_scc1 K2_JT
    s_cmp_lt_u32 s3, 8
    s_cbranch_scc1 K2_JW
    s_cmp_lt_u32 s3, 11
    s_cbranch_scc1 K2_JH
    s_waitcnt vmcnt(0)
    s_branch K2_JDONE
K2_JT:
    s_add_u32 s17, s17, 12288
    buffer_load_dwordx4 v[58:61], v8, s[28:31], s17 offen sc1
    s_lshl_b32 s17, s3, 10
    s_add_u32 s17, s17, 12288
    v_add_u32 v9, s17, v8
    s_waitcnt vmcnt(0)
    ds_write_b128 v9, v[58:61]
    s_branch K2_JDONE
K2_JW:
    s_sub_u32 s62, s3, 5
    s_lshl_b32 s62, s62, 10
    s_mul_i32 s17, s13, 3072
    s_add_u32 s17, s17, s62
    buffer_load_dwordx4 v[58:61], v8, s[40:43], s17 offen sc1
    s_add_u32 s62, s62, 131072
    v_add_u32 v9, s62, v8
    s_waitcnt vmcnt(0)
    ds_write_b128 v9, v[58:61]
    s_branch K2_JDONE
K2_JH:
    s_sub_u32 s62, s3, 8
    s_sub_u32 s17, s14, s3
    s_lshl_b32 s17, s17, 2
    s_lshl_b32 s61, s62, 4
    s_add_u32 s17, s17, s61
    v_mul_u32_u24 v6, 3072, v166
    buffer_load_dwordx4 v[58:61], v6, s[20:23], s17 offen sc1
    s_lshl_b32 s62, s62, 10
    s_add_u32 s62, s62, 135168
    v_lshlrev_b32 v9, 2, v166
    v_add_u32 v9, s62, v9
    s_waitcnt vmcnt(0)
    ds_write_b32 v9, v58 offset:0
    ds_write_b32 v9, v59 offset:256
    ds_write_b32 v9, v60 offset:512
    ds_write_b32 v9, v61 offset:768
    v_lshrrev_b32 v62, 16, v58
    v_and_b32 v64, 0xffff0000, v59
    v_or_b32 v62, v62, v64
    v_lshrrev_b32 v63, 16, v60
    v_and_b32 v64, 0xffff0000, v61
    v_or_b32 v63, v63, v64
    s_nop 1
    v_add_u32_dpp v62, v62, v62 row_shr:1 row_mask:0xf bank_mask:0xf
    v_add_u32_dpp v63, v63, v63 row_shr:1 row_mask:0xf bank_mask:0xf
    s_nop 0
    v_add_u32_dpp v62, v62, v62 row_shr:2 row_mask:0xf bank_mask:0xf
    v_add_u32_dpp v63, v63, v63 row_shr:2 row_mask:0xf bank_mask:0xf
    s_nop 0
    v_add_u32_dpp v62, v62, v62 row_shr:4 row_mask:0xf bank_mask:0xf
    v_add_u32_dpp v63, v63, v63 row_shr:4 row_mask:0xf bank_mask:0xf
    s_nop 0
    v_add_u32_dpp v62, v62, v62 row_shr:8 row_mask:0xf bank_mask:0xf
    v_add_u32_dpp v63, v63, v63 row_shr:8 row_mask:0xf bank_mask:0xf
    s_nop 0
    v_add_u32_dpp v62, v62, v62 row_bcast:15 row_mask:0xa bank_mask:0xf
    v_add_u32_dpp v63, v63, v63 row_bcast:15 row_mask:0xa bank_mask:0xf
    s_nop 0
    v_add_u32_dpp v62, v62, v62 row_bcast:31 row_mask:0xc bank_mask:0xf
    v_add_u32_dpp v63, v63, v63 row_bcast:31 row_mask:0xc bank_mask:0xf
    s_nop 0
    v_readlane_b32 s56, v62, 63
    v_readlane_b32 s57, v63, 63
    s_sub_u32 s61, s3, 8
    s_lshl_b32 s61, s61, 2
    s_and_b32 s63, s56, 0xffff
    s_add_u32 s63, s63, 15
    s_and_b32 s63, s63, 0xfffff0
    s_add_u32 s63, s63, 15
    s_sub_u32 s63, s63, s61
    v_mov_b32 v62, s63
    s_lshr_b32 s63, s56, 16
    s_add_u32 s63, s63, 15
    s_and_b32 s63, s63, 0xfffff0
    s_add_u32 s63, s63, 15
    s_sub_u32 s63, s63, s61
    s_sub_u32 s63, s63, 1
    v_mov_b32 v63, s63
    s_and_b32 s63, s57, 0xffff
    s_add_u32 s63, s63, 15
    s_and_b32 s63, s63, 0xfffff0
    s_add_u32 s63, s63, 15
    s_sub_u32 s63, s63, s61
    s_sub_u32 s63, s63, 2
    v_mov_b32 v64, s63
    s_lshr_b32 s63, s57, 16
    s_add_u32 s63, s63, 15
    s_and_b32 s63, s63, 0xfffff0
    s_add_u32 s63, s63, 15
    s_sub_u32 s63, s63, s61
    s_sub_u32 s63, s63, 3
    v_mov_b32 v65, s63
    s_lshl_b32 s61, s61, 2
    s_add_u32 s61, s61, 139264
    v_mov_b32 v9, s61
    s_mov_b64 exec, 1
    ds_write_b128 v9, v[62:65]
    s_mov_b64 exec, -1
K2_JDONE:
    s_lshl_b32 s17, s3, 10
    v_add_u32 v8, s17, v8
    ds_write_b128 v8, v[54:57]
    s_waitcnt lgkmcnt(0)
    s_barrier
    v_lshlrev_b32 v8, 2, v166
    v_add_u32 v9, 139264, v8
    ds_read_b32 v7, v9
    v_mov_b32 v9, 139264
    ds_read_b128 v[54:57], v9 offset:0
    ds_read_b128 v[58:61], v9 offset:16
    ds_read_b128 v[62:65], v9 offset:32
    s_sub_u32 s17, 11, s3
    s_cmp_lt_u32 s3, 4
    s_cselect_b32 s17, s3, s17
    s_sub_u32 s19, 19, s3
    s_cmp_ge_u32 s3, 8
    s_cselect_b32 s17, s19, s17
    v_mov_b32 v6, 0
    s_waitcnt lgkmcnt(0)
    v_sub_u32 v54, v7, v54
    v_sub_u32 v55, v7, v55
    v_sub_u32 v56, v7, v56
    v_sub_u32 v57, v7, v57
    v_sub_u32 v58, v7, v58
    v_sub_u32 v59, v7, v59
    v_sub_u32 v60, v7, v60
    v_sub_u32 v61, v7, v61
    v_sub_u32 v62, v7, v62
    v_sub_u32 v63, v7, v63
    v_sub_u32 v64, v7, v64
    v_sub_u32 v65, v7, v65
    v_lshrrev_b32 v54, 31, v54
    v_lshrrev_b32 v55, 31, v55
    v_lshrrev_b32 v56, 31, v56
    v_lshrrev_b32 v57, 31, v57
    v_lshrrev_b32 v58, 31, v58
    v_lshrrev_b32 v59, 31, v59
    v_lshrrev_b32 v60, 31, v60
    v_lshrrev_b32 v61, 31, v61
    v_lshrrev_b32 v62, 31, v62
    v_lshrrev_b32 v63, 31, v63
    v_lshrrev_b32 v64, 31, v64
    v_lshrrev_b32 v65, 31, v65
    v_add3_u32 v6, v6, v54, v55
    v_add3_u32 v6, v6, v56, v57
    v_add3_u32 v6, v6, v58, v59
    v_add3_u32 v6, v6, v60, v61
    v_add3_u32 v6, v6, v62, v63
    v_add3_u32 v6, v6, v64, v65
    v_cmp_eq_u32 vcc, s17, v6
    s_and_b32 s17, vcc_lo, 0xfff
    s_ff1_i32_b32 s17, s17
    s_sub_u32 s14, s14, s3
    s_add_u32 s14, s14, s17
    s_mul_i32 s15, s14, 853362
    s_add_u32 s16, s15, 65000
    s_lshr_b32 s15, s16, 16
    s_add_u32 s16, s16, 853362
    s_lshr_b32 s16, s16, 16
    s_min_u32 s16, s16, 10000
    s_sub_u32 s16, s16, s15
    s_lshl_b32 s17, s17, 8
    s_add_u32 s17, s17, 135168
    v_add_u32 v8, s17, v8
    ds_read_b32 v7, v8
    v_lshlrev_b32 v8, 4, v166
    v_add_u32 v8, 131072, v8
    ds_read_b128 v[10:13], v8 offset:0
    ds_read_b128 v[14:17], v8 offset:1024
    ds_read_b128 v[18:21], v8 offset:2048
    s_waitcnt lgkmcnt(3)
    v_lshrrev_b32 v154, 16, v7
    v_and_b32 v155, 0xffff, v7
    v_mov_b32 v156, v154
    s_nop 1
    v_add_u32_dpp v156, v156, v156 row_shr:1 row_mask:0xf bank_mask:0xf
    s_nop 1
    v_add_u32_dpp v156, v156, v156 row_shr:2 row_mask:0xf bank_mask:0xf
    s_nop 1
    v_add_u32_dpp v156, v156, v156 row_shr:4 row_mask:0xf bank_mask:0xf
    s_nop 1
    v_add_u32_dpp v156, v156, v156 row_shr:8 row_mask:0xf bank_mask:0xf
    s_nop 1
    v_add_u32_dpp v156, v156, v156 row_bcast:15 row_mask:0xa bank_mask:0xf
    s_nop 1
    v_add_u32_dpp v156, v156, v156 row_bcast:31 row_mask:0xc bank_mask:0xf
    s_nop 1
    v_readlane_b32 s19, v156, 63
    v_sub_u32 v156, v156, v154
    v_lshl_add_u32 v157, v166, 12, v155
K2_CHUNK:
    v_sub_u32 v158, s52, v156
    v_max_i32 v158, 0, v158
    s_cmp_gt_u32 s19, 256
    s_cbranch_scc1 K2_FILL
    v_lshlrev_b32 v159, 2, v156
    v_add_u32 v159, s18, v159
    v_mov_b32 v160, v157
    v_cmp_lt_u32 vcc, 0, v154
    s_cbranch_vccz K2_FILL_DONE
    s_mov_b64 exec, vcc
    ds_write_b32 v159, v160 offset:0
    v_add_u32 v160, 1, v160
    v_cmp_lt_u32 vcc, 1, v154
    s_cbranch_vccz K2_FILL_DONE
    s_mov_b64 exec, vcc
    ds_write_b32 v159, v160 offset:4
    v_add_u32 v160, 1, v160
    v_cmp_lt_u32 vcc, 2, v154
    s_cbranch_vccz K2_FILL_DONE
    s_mov_b64 exec, vcc
    ds_write_b32 v159, v160 offset:8
    v_add_u32 v160, 1, v160
    v_cmp_lt_u32 vcc, 3, v154
    s_cbranch_vccz K2_FILL_DONE
    s_mov_b64 exec, vcc
    ds_write_b32 v159, v160 offset:12
    v_add_u32 v160, 1, v160
    v_cmp_lt_u32 vcc, 4, v154
    s_cbranch_vccz K2_FILL_DONE
    s_mov_b64 exec, vcc
    ds_write_b32 v159, v160 offset:16
    v_add_u32 v160, 1, v160
    v_cmp_lt_u32 vcc, 5, v154
    s_cbranch_vccz K2_FILL_DONE
    s_mov_b64 exec, vcc
    ds_write_b32 v159, v160 offset:20
    v_add_u32 v160, 1, v160
    v_cmp_lt_u32 vcc, 6, v154
    s_cbranch_vccz K2_FILL_DONE
    s_mov_b64 exec, vcc
    ds_write_b32 v159, v160 offset:24
    v_add_u32 v160, 1, v160
    v_cmp_lt_u32 vcc, 7, v154
    s_cbranch_vccz K2_FILL_DONE
    s_mov_b64 exec, vcc
    ds_write_b32 v159, v160 offset:28
    v_add_u32 v160, 1, v160
    v_cmp_lt_u32 vcc, 8, v154
    s_cbranch_vccz K2_FILL_DONE
    s_mov_b64 exec, vcc
    ds_write_b32 v159, v160 offset:32
    v_add_u32 v160, 1, v160
    v_cmp_lt_u32 vcc, 9, v154
    s_cbranch_vccz K2_FILL_DONE
    s_mov_b64 exec, vcc
    ds_write_b32 v159, v160 offset:36
    v_add_u32 v160, 1, v160
    v_cmp_lt_u32 vcc, 10, v154
    s_cbranch_vccz K2_FILL_DONE
    s_mov_b64 exec, vcc
    ds_write_b32 v159, v160 offset:40
    v_add_u32 v160, 1, v160
    v_cmp_lt_u32 vcc, 11, v154
    s_cbranch_vccz K2_FILL_DONE
    s_mov_b64 exec, vcc
    ds_write_b32 v159, v160 offset:44
    v_add_u32 v160, 1, v160
    s_mov_b64 exec, -1
    v_mov_b32 v158, 12
K2_FILL:
    v_add_u32 v159, v156, v158
    v_subrev_u32 v159, s52, v159
    v_cmp_lt_u32 s[56:57], v158, v154
    v_cmp_gt_u32 vcc, 256, v159
    s_and_b64 vcc, vcc, s[56:57]
    s_cbranch_vccz K2_FILL_DONE
    v_lshlrev_b32 v159, 2, v159
    v_add_u32 v159, s18, v159
    v_add_u32 v160, v157, v158
    s_mov_b64 exec, vcc
    ds_write_b32 v159, v160
    s_mov_b64 exec, -1
    v_add_u32 v158, 1, v158
    s_branch K2_FILL
K2_FILL_DONE:
    s_mov_b64 exec, -1
    s_sub_u32 s55, s19, s52
    s_min_u32 s55, s55, 256
    s_add_u32 s58, s55, 31
    s_lshr_b32 s58, s58, 5
    s_lshl_b32 s59, s58, 5
    s_add_u32 s59, s59, 32
    s_and_b32 s54, s55, 31
    s_sub_u32 s54, s54, 1
    s_cmp_lt_u32 s54, 16
    s_cselect_b32 s54, 1, 0
    s_sub_u32 s58, s58, s54
    v_lshlrev_b32 v6, 2, v166
    v_add_u32 v6, s18, v6
    ds_read_b32 v86, v6 offset:0
    ds_read_b32 v87, v6 offset:256
    ds_read_b32 v88, v6 offset:512
    ds_read_b32 v89, v6 offset:768
    ds_read_b32 v90, v6 offset:1024
    v_mov_b32 v8, 0x80000000
    v_add_u32 v7, 0, v166
    v_cmp_gt_u32 vcc, s55, v7
    s_waitcnt lgkmcnt(4)
    v_lshlrev_b32 v86, 4, v86
    v_cndmask_b32 v86, v8, v86, vcc
    buffer_load_dwordx4 v[94:97], v86, s[24:27], 0 offen sc1
    s_cmp_le_u32 s59, 64
    s_cbranch_scc1 K2_REC_ISSUED
    v_add_u32 v7, 64, v166
    v_cmp_gt_u32 vcc, s55, v7
    s_waitcnt lgkmcnt(3)
    v_lshlrev_b32 v87, 4, v87
    v_cndmask_b32 v87, v8, v87, vcc
    buffer_load_dwordx4 v[98:101], v87, s[24:27], 0 offen sc1
    s_cmp_le_u32 s59, 128
    s_cbranch_scc1 K2_REC_ISSUED
    v_add_u32 v7, 128, v166
    v_cmp_gt_u32 vcc, s55, v7
    s_waitcnt lgkmcnt(2)
    v_lshlrev_b32 v88, 4, v88
    v_cndmask_b32 v88, v8, v88, vcc
    buffer_load_dwordx4 v[102:105], v88, s[24:27], 0 offen sc1
    s_cmp_le_u32 s59, 192
    s_cbranch_scc1 K2_REC_ISSUED
    v_add_u32 v7, 192, v166
    v_cmp_gt_u32 vcc, s55, v7
    s_waitcnt lgkmcnt(1)
    v_lshlrev_b32 v89, 4, v89
    v_cndmask_b32 v89, v8, v89, vcc
    buffer_load_dwordx4 v[106:109], v89, s[24:27], 0 offen sc1
    s_cmp_le_u32 s59, 256
    s_cbranch_scc1 K2_REC_ISSUED
    v_add_u32 v7, 256, v166
    v_cmp_gt_u32 vcc, s55, v7
    s_waitcnt lgkmcnt(0)
    v_lshlrev_b32 v90, 4, v90
    v_cndmask_b32 v90, v8, v90, vcc
    buffer_load_dwordx4 v[110:113], v90, s[24:27], 0 offen sc1
K2_REC_ISSUED:
    s_or_b32 s62, s3, s52
    s_cmp_lg_u32 s62, 0
    s_cbranch_scc1 K2_NOPB
    v_mbcnt_lo_u32_b32 v167, -1, 0
    v_mbcnt_hi_u32_b32 v167, -1, v167
    v_lshlrev_b32 v167, 4, v167
    s_add_u32 s64, s10, 0xcf0000
    s_addc_u32 s65, s11, 0
    s_mov_b32 s66, 16384
    s_mov_b32 s67, 0x00020000
    s_and_b32 s62, s2, 7
    s_lshl_b32 s62, s62, 11
    buffer_load_dwordx4 v[162:165], v167, s[64:67], s62 offen offset:0 sc1
K2_NOPB:
    v_mbcnt_lo_u32_b32 v166, -1, 0
    v_mbcnt_hi_u32_b32 v166, -1, v166
    v_and_b32 v6, 3, v166
    v_lshlrev_b32 v6, 3, v6
    v_bfe_u32 v7, v166, 2, 3
    v_or_b32 v6, v6, v7
    v_and_b32 v7, 32, v166
    v_or_b32 v9, v6, v7
    v_lshlrev_b32 v6, 2, v9
    v_add_u32 v6, s18, v6
    v_lshrrev_b32 v160, 4, v166
    v_lshlrev_b32 v3, 5, v160
    v_add_u32 v3, s18, v3
    v_lshlrev_b32 v4, 4, v160
    v_add_u32 v4, s18, v4
    v_lshrrev_b32 v160, 2, v0
    v_and_b32 v161, 3, v0
    v_lshl_add_u32 v160, v160, 3, v161
    v_lshlrev_b32 v5, 2, v160
    v_add_u32 v5, s18, v5
    v_lshlrev_b32 v7, 1, v9
    v_add_u32 v7, s18, v7
    s_waitcnt vmcnt(0) lgkmcnt(0)
    s_or_b32 s62, s3, s52
    s_cmp_lg_u32 s62, 0
    s_cbranch_scc1 K2_PB_DONE
    s_mov_b32 s61, 0x8000
    v_cmp_eq_u32 s[56:57], s100, v162
    v_cmp_eq_u32 s[62:63], s100, v163
    v_cmp_eq_u32 vcc, s100, v164
    s_and_b64 s[56:57], s[56:57], s[62:63]
    s_and_b64 s[56:57], s[56:57], vcc
    v_cmp_eq_u32 vcc, s100, v165
    s_and_b64 s[56:57], s[56:57], vcc
    s_cmp_eq_u64 s[56:57], -1
    s_cbranch_scc1 K2_PB_OK
    v_mbcnt_lo_u32_b32 v167, -1, 0
    v_mbcnt_hi_u32_b32 v167, -1, v167
    v_lshlrev_b32 v167, 4, v167
    s_add_u32 s64, s10, 0xcf0000
    s_addc_u32 s65, s11, 0
    s_mov_b32 s66, 16384
    s_mov_b32 s67, 0x00020000
    s_and_b32 s62, s2, 7
    s_lshl_b32 s62, s62, 11
    buffer_load_dwordx4 v[162:165], v167, s[64:67], s62 offen offset:0 sc1
    s_sleep 3
    v_mbcnt_lo_u32_b32 v167, -1, 0
    v_mbcnt_hi_u32_b32 v167, -1, v167
    v_lshlrev_b32 v167, 4, v167
    s_add_u32 s64, s10, 0xcf0000
    s_addc_u32 s65, s11, 0
    s_mov_b32 s66, 16384
    s_mov_b32 s67, 0x00020000
    s_and_b32 s62, s2, 7
    s_lshl_b32 s62, s62, 11
    buffer_load_dwordx4 v[78:81], v167, s[64:67], s62 offen offset:0 sc1
K2_POLLB:
    s_sleep 3
    v_mbcnt_lo_u32_b32 v167, -1, 0
    v_mbcnt_hi_u32_b32 v167, -1, v167
    v_lshlrev_b32 v167, 4, v167
    s_add_u32 s64, s10, 0xcf0000
    s_addc_u32 s65, s11, 0
    s_mov_b32 s66, 16384
    s_mov_b32 s67, 0x00020000
    s_and_b32 s62, s2, 7
    s_lshl_b32 s62, s62, 11
    buffer_load_dwordx4 v[82:85], v167, s[64:67], s62 offen offset:0 sc1
    s_waitcnt vmcnt(2)
    v_cmp_eq_u32 s[56:57], s100, v162
    v_cmp_eq_u32 s[62:63], s100, v163
    v_cmp_eq_u32 vcc, s100, v164
    s_and_b64 s[56:57], s[56:57], s[62:63]
    s_and_b64 s[56:57], s[56:57], vcc
    v_cmp_eq_u32 vcc, s100, v165
    s_and_b64 s[56:57], s[56:57], vcc
    s_cmp_eq_u64 s[56:57], -1
    s_cbranch_scc1 K2_PB_OK0
    s_sleep 3
    v_mbcnt_lo_u32_b32 v167, -1, 0
    v_mbcnt_hi_u32_b32 v167, -1, v167
    v_lshlrev_b32 v167, 4, v167
    s_add_u32 s64, s10, 0xcf0000
    s_addc_u32 s65, s11, 0
    s_mov_b32 s66, 16384
    s_mov_b32 s67, 0x00020000
    s_and_b32 s62, s2, 7
    s_lshl_b32 s62, s62, 11
    buffer_load_dwordx4 v[162:165], v167, s[64:67], s62 offen offset:0 sc1
    s_waitcnt vmcnt(2)
    v_cmp_eq_u32 s[56:57], s100, v78
    v_cmp_eq_u32 s[62:63], s100, v79
    v_cmp_eq_u32 vcc, s100, v80
    s_and_b64 s[56:57], s[56:57], s[62:63]
    s_and_b64 s[56:57], s[56:57], vcc
    v_cmp_eq_u32 vcc, s100, v81
    s_and_b64 s[56:57], s[56:57], vcc
    s_cmp_eq_u64 s[56:57], -1
    s_cbranch_scc1 K2_PB_OK0
    s_sleep 3
    v_mbcnt_lo_u32_b32 v167, -1, 0
    v_mbcnt_hi_u32_b32 v167, -1, v167
    v_lshlrev_b32 v167, 4, v167
    s_add_u32 s64, s10, 0xcf0000
    s_addc_u32 s65, s11, 0
    s_mov_b32 s66, 16384
    s_mov_b32 s67, 0x00020000
    s_and_b32 s62, s2, 7
    s_lshl_b32 s62, s62, 11
    buffer_load_dwordx4 v[78:81], v167, s[64:67], s62 offen offset:0 sc1
    s_waitcnt vmcnt(2)
    v_cmp_eq_u32 s[56:57], s100, v82
    v_cmp_eq_u32 s[62:63], s100, v83
    v_cmp_eq_u32 vcc, s100, v84
    s_and_b64 s[56:57], s[56:57], s[62:63]
    s_and_b64 s[56:57], s[56:57], vcc
    v_cmp_eq_u32 vcc, s100, v85
    s_and_b64 s[56:57], s[56:57], vcc
    s_cmp_eq_u64 s[56:57], -1
    s_cbranch_scc1 K2_PB_OK0
    s_sub_u32 s61, s61, 1
    s_cmp_lg_u32 s61, 0
    s_cbranch_scc1 K2_POLLB
K2_PB_OK0:
    s_waitcnt vmcnt(0)
K2_PB_OK:
    v_mov_b32 v162, 18176
    v_mov_b32 v163, 1
    ds_write_b32 v162, v163
K2_PB_DONE:
    v_xor_b32 v94, v8, v94
    v_add_u32 v97, 17408, v97
    ds_write_b32 v6, v94 offset:0
    ds_write_b32 v6, v97 offset:1280
    ds_read_b128 v[154:157], v3 offset:0
    ds_read_b128 v[158:161], v3 offset:16
    v_mov_b32 v162, 18176
    s_mov_b32 s61, 0x200000
K2_TSPIN:
    ds_read_b32 v163, v162
    s_waitcnt lgkmcnt(0)
    v_readfirstlane_b32 s62, v163
    s_cmp_lg_u32 s62, 0
    s_cbranch_scc1 K2_TOK
    s_sub_u32 s61, s61, 1
    s_cmp_lg_u32 s61, 0
    s_cbranch_scc1 K2_TSPIN
K2_TOK:
    s_add_u32 s53, s58, s54
    s_cmp_eq_u32 s53, 0
    s_cbranch_scc1 K2_NOTILES
    v_add_u32 v166, v154, v0
    buffer_load_dwordx4 v[54:57], v166, s[44:47], 0 idxen sc1
    buffer_load_dword v86, v166, s[48:51], 0 idxen sc1
    v_add_u32 v167, v155, v0
    buffer_load_dwordx4 v[58:61], v167, s[44:47], 0 idxen sc1
    buffer_load_dword v87, v167, s[48:51], 0 idxen sc1
    v_add_u32 v166, v156, v0
    buffer_load_dwordx4 v[62:65], v166, s[44:47], 0 idxen sc1
    buffer_load_dword v88, v166, s[48:51], 0 idxen sc1
    v_add_u32 v167, v157, v0
    buffer_load_dwordx4 v[66:69], v167, s[44:47], 0 idxen sc1
    buffer_load_dword v89, v167, s[48:51], 0 idxen sc1
    ds_write_b16 v7, v95 offset:3200
    ds_write_b16_d16_hi v7, v95 offset:3840
    ds_write_b16 v7, v96 offset:4480
    ds_write_b16_d16_hi v7, v96 offset:2560
    s_cmp_le_u32 s59, 64
    s_cbranch_scc1 K2_SOA_DONE
    v_xor_b32 v98, v8, v98
    v_add_u32 v101, 17408, v101
    ds_write_b32 v6, v98 offset:256
    ds_write_b32 v6, v101 offset:1536
    ds_write_b16 v7, v99 offset:3328
    ds_write_b16_d16_hi v7, v99 offset:3968
    ds_write_b16 v7, v100 offset:4608
    ds_write_b16_d16_hi v7, v100 offset:2688
    s_cmp_le_u32 s59, 128
    s_cbranch_scc1 K2_SOA_DONE
    v_xor_b32 v102, v8, v102
    v_add_u32 v105, 17408, v105
    ds_write_b32 v6, v102 offset:512
    ds_write_b32 v6, v105 offset:1792
    ds_write_b16 v7, v103 offset:3456
    ds_write_b16_d16_hi v7, v103 offset:4096
    ds_write_b16 v7, v104 offset:4736
    ds_write_b16_d16_hi v7, v104 offset:2816
    s_cmp_le_u32 s59, 192
    s_cbranch_scc1 K2_SOA_DONE
    v_xor_b32 v106, v8, v106
    v_add_u32 v109, 17408, v109
    ds_write_b32 v6, v106 offset:768
    ds_write_b32 v6, v109 offset:2048
    ds_write_b16 v7, v107 offset:3584
    ds_write_b16_d16_hi v7, v107 offset:4224
    ds_write_b16 v7, v108 offset:4864
    ds_write_b16_d16_hi v7, v108 offset:2944
    s_cmp_le_u32 s59, 256
    s_cbranch_scc1 K2_SOA_DONE
    v_xor_b32 v110, v8, v110
    v_add_u32 v113, 17408, v113
    ds_write_b32 v6, v110 offset:1024
    ds_write_b32 v6, v113 offset:2304
    ds_write_b16 v7, v111 offset:3712
    ds_write_b16_d16_hi v7, v111 offset:4352
    ds_write_b16 v7, v112 offset:4992
    ds_write_b16_d16_hi v7, v112 offset:3072
K2_SOA_DONE:
    ds_read_b32 v8, v5 offset:1280
    ds_read_b32 v9, v5 offset:1296
    v_add_u32 v166, v158, v0
    buffer_load_dwordx4 v[70:73], v166, s[44:47], 0 idxen sc1
    buffer_load_dword v90, v166, s[48:51], 0 idxen sc1
    v_add_u32 v167, v159, v0
    buffer_load_dwordx4 v[74:77], v167, s[44:47], 0 idxen sc1
    buffer_load_dword v91, v167, s[48:51], 0 idxen sc1
    v_add_u32 v166, v160, v0
    buffer_load_dwordx4 v[78:81], v166, s[44:47], 0 idxen sc1
    buffer_load_dword v92, v166, s[48:51], 0 idxen sc1
    v_add_u32 v167, v161, v0
    buffer_load_dwordx4 v[82:85], v167, s[44:47], 0 idxen sc1
    buffer_load_dword v93, v167, s[48:51], 0 idxen sc1
    s_waitcnt lgkmcnt(0)
    v_or_b32 v166, v8, v9
    v_cmp_gt_i32 vcc, 0, v166
    s_cbranch_vccnz K2_RARE0
    v_add_u32 v8, v8, v2
    v_add_u32 v9, v9, v2
    ds_read_b64 v[162:163], v8
    ds_read_b64 v[164:165], v9
K2_RARE_BACK0:
    s_waitcnt lgkmcnt(0)
    v_mfma_f32_16x16x16_bf16 v[102:105], v[162:163], v[14:15], 0
    v_mfma_f32_16x16x16_bf16 v[110:113], v[162:163], v[18:19], 0
    v_mfma_f32_16x16x16_bf16 v[94:97], v[162:163], v[10:11], 0
    v_mov_b32 v6, 0
    v_mov_b32 v7, 0
    v_mov_b32 v8, 0
    v_mov_b32 v9, 0
    s_nop 3
    s_mov_b32 s53, 0
    s_cmp_eq_u32 s58, 0
    s_cbranch_scc1 K2_HALF
K2_TILE:
    s_cmp_ge_u32 s58, 4
    s_cbranch_scc1 K2_P2
    s_cmp_ge_u32 s58, 2
    s_cbranch_scc1 K2_P1
    s_setprio 0
    s_branch K2_PDONE
K2_P1:
    s_setprio 1
    s_branch K2_PDONE
K2_P2:
    s_setprio 2
K2_PDONE:
    s_waitcnt vmcnt(8)
    v_mfma_f32_16x16x32_bf16 v[34:37], v[142:145], v[130:133], v[34:37]
    v_cvt_pk_bf16_f32 v136, v6, v7
    v_cvt_pk_bf16_f32 v137, v8, v9
    v_lshlrev_b32 v6, 16, v54
    v_lshlrev_b32 v7, 16, v58
    v_lshlrev_b32 v8, 16, v62
    v_lshlrev_b32 v9, 16, v66
    v_pk_mul_f32 v[6:7], v[6:7], v[102:103]
    v_pk_mul_f32 v[8:9], v[8:9], v[104:105]
    v_mfma_f32_16x16x32_bf16 v[42:45], v[146:149], v[130:133], v[42:45]
    v_cvt_pk_bf16_f32 v118, v6, v7
    v_cvt_pk_bf16_f32 v119, v8, v9
    v_lshlrev_b32 v6, 16, v55
    v_lshlrev_b32 v7, 16, v59
    v_lshlrev_b32 v8, 16, v63
    v_lshlrev_b32 v9, 16, v67
    v_pk_mul_f32 v[6:7], v[6:7], v[102:103]
    v_pk_mul_f32 v[8:9], v[8:9], v[104:105]
    v_mfma_f32_16x16x32_bf16 v[50:53], v[150:153], v[130:133], v[50:53]
    v_cvt_pk_bf16_f32 v122, v6, v7
    v_cvt_pk_bf16_f32 v123, v8, v9
    v_lshlrev_b32 v6, 16, v56
    v_lshlrev_b32 v7, 16, v60
    v_lshlrev_b32 v8, 16, v64
    v_lshlrev_b32 v9, 16, v68
    v_pk_mul_f32 v[6:7], v[6:7], v[102:103]
    v_pk_mul_f32 v[8:9], v[8:9], v[104:105]
    v_mfma_f32_16x16x32_bf16 v[26:29], v[138:141], v[134:137], v[26:29]
    v_cvt_pk_bf16_f32 v126, v6, v7
    v_cvt_pk_bf16_f32 v127, v8, v9
    v_lshlrev_b32 v6, 16, v57
    v_lshlrev_b32 v7, 16, v61
    v_lshlrev_b32 v8, 16, v65
    v_lshlrev_b32 v9, 16, v69
    v_pk_mul_f32 v[6:7], v[6:7], v[110:111]
    v_pk_mul_f32 v[8:9], v[8:9], v[112:113]
    v_mfma_f32_16x16x16_bf16 v[102:105], v[162:163], v[16:17], 0
    ds_read_b128 v[138:141], v4 offset:2560
    ds_read_b128 v[142:145], v4 offset:3200
    ds_read_b128 v[146:149], v4 offset:3840
    ds_read_b128 v[150:153], v4 offset:4480
    ds_read_b128 v[154:157], v3 offset:128
    ds_read_b128 v[158:161], v3 offset:144
    v_mfma_f32_16x16x16_bf16 v[106:109], v[164:165], v[14:15], 0
    v_cvt_pk_bf16_f32 v130, v6, v7
    v_cvt_pk_bf16_f32 v131, v8, v9
    v_lshlrev_b32 v6, 16, v86
    v_lshlrev_b32 v7, 16, v87
    v_lshlrev_b32 v8, 16, v88
    v_lshlrev_b32 v9, 16, v89
    v_pk_mul_f32 v[6:7], v[6:7], v[94:95]
    v_pk_mul_f32 v[8:9], v[8:9], v[96:97]
    s_waitcnt vmcnt(0)
    s_cmp_lt_u32 s53, 3
    s_cbranch_scc1 K2_RESSKIP
    s_cmp_lg_u32 s60, 0
    s_cbranch_scc1 K2_RESDONEA
    s_mov_b32 s60, 1
    v_mbcnt_lo_u32_b32 v166, -1, 0
    v_mbcnt_hi_u32_b32 v166, -1, v166
    v_and_b32 v167, 3, v166
    v_lshlrev_b32 v167, 4, v167
    v_lshrrev_b32 v166, 2, v166
    v_lshl_add_u32 v167, v166, 8, v167
    s_lshl_b32 s61, s15, 10
    s_lshl_b32 s62, s13, 6
    s_add_u32 s61, s61, s62
    s_lshl_b32 s62, s3, 12
    s_add_u32 s62, s62, 79872
    s_mov_b32 m0, s62
    s_add_u32 s62, s62, 1024
    buffer_load_dwordx4 v167, s[32:35], s61 offen  lds
    s_add_u32 s61, s61, 4096
    s_mov_b32 m0, s62
    s_add_u32 s62, s62, 1024
    buffer_load_dwordx4 v167, s[32:35], s61 offen  lds
    s_add_u32 s61, s61, 4096
    s_mov_b32 m0, s62
    s_add_u32 s62, s62, 1024
    buffer_load_dwordx4 v167, s[32:35], s61 offen  lds
    s_add_u32 s61, s61, 4096
    s_mov_b32 m0, s62
    s_add_u32 s62, s62, 1024
    buffer_load_dwordx4 v167, s[32:35], s61 offen  lds
    s_add_u32 s61, s61, 4096
K2_RESDONEA:
K2_RESSKIP:
    v_mfma_f32_16x16x16_bf16 v[114:117], v[164:165], v[18:19], 0
    v_cvt_pk_bf16_f32 v134, v6, v7
    v_cvt_pk_bf16_f32 v135, v8, v9
    v_lshlrev_b32 v6, 16, v70
    v_lshlrev_b32 v7, 16, v74
    v_lshlrev_b32 v8, 16, v78
    v_lshlrev_b32 v9, 16, v82
    v_pk_mul_f32 v[6:7], v[6:7], v[106:107]
    v_pk_mul_f32 v[8:9], v[8:9], v[108:109]
    v_mfma_f32_16x16x16_bf16 v[98:101], v[164:165], v[10:11], 0
    v_cvt_pk_bf16_f32 v120, v6, v7
    v_cvt_pk_bf16_f32 v121, v8, v9
    v_lshlrev_b32 v6, 16, v71
    v_lshlrev_b32 v7, 16, v75
    v_lshlrev_b32 v8, 16, v79
    v_lshlrev_b32 v9, 16, v83
    v_pk_mul_f32 v[6:7], v[6:7], v[106:107]
    v_pk_mul_f32 v[8:9], v[8:9], v[108:109]
    s_waitcnt lgkmcnt(2)
    v_mfma_f32_16x16x16_bf16 v[110:113], v[162:163], v[20:21], 0
    v_pk_lshlrev_b16 v138, v1, v138
    v_pk_lshlrev_b16 v139, v1, v139
    v_pk_lshlrev_b16 v140, v1, v140
    v_pk_lshlrev_b16 v141, v1, v141
    v_pk_ashrrev_i16 v138, 15, v138 op_sel_hi:[0,1]
    v_pk_ashrrev_i16 v139, 15, v139 op_sel_hi:[0,1]
    v_pk_ashrrev_i16 v140, 15, v140 op_sel_hi:[0,1]
    v_pk_ashrrev_i16 v141, 15, v141 op_sel_hi:[0,1]
    v_mfma_f32_16x16x16_bf16 v[94:97], v[162:163], v[12:13], 0
    v_and_b32 v142, v138, v142
    v_and_b32 v143, v139, v143
    v_and_b32 v144, v140, v144
    v_and_b32 v145, v141, v145
    v_and_b32 v146, v138, v146
    v_and_b32 v147, v139, v147
    v_and_b32 v148, v140, v148
    v_and_b32 v149, v141, v149
    v_and_b32 v150, v138, v150
    v_and_b32 v151, v139, v151
    v_and_b32 v152, v140, v152
    v_and_b32 v153, v141, v153
    v_and_b32 v138, 0x3f803f80, v138
    v_and_b32 v139, 0x3f803f80, v139
    v_and_b32 v140, 0x3f803f80, v140
    v_and_b32 v141, 0x3f803f80, v141
    v_add_u32 v3, 128, v3
    v_add_u32 v4, 64, v4
    v_mfma_f32_16x16x32_bf16 v[30:33], v[138:141], v[118:121], v[30:33]
    v_cvt_pk_bf16_f32 v124, v6, v7
    v_cvt_pk_bf16_f32 v125, v8, v9
    v_lshlrev_b32 v6, 16, v72
    v_lshlrev_b32 v7, 16, v76
    v_lshlrev_b32 v8, 16, v80
    v_lshlrev_b32 v9, 16, v84
    v_pk_mul_f32 v[6:7], v[6:7], v[106:107]
    v_pk_mul_f32 v[8:9], v[8:9], v[108:109]
    v_mfma_f32_16x16x32_bf16 v[38:41], v[138:141], v[122:125], v[38:41]
    v_cvt_pk_bf16_f32 v128, v6, v7
    v_cvt_pk_bf16_f32 v129, v8, v9
    v_lshlrev_b32 v6, 16, v73
    v_lshlrev_b32 v7, 16, v77
    v_lshlrev_b32 v8, 16, v81
    v_lshlrev_b32 v9, 16, v85
    v_pk_mul_f32 v[6:7], v[6:7], v[114:115]
    v_pk_mul_f32 v[8:9], v[8:9], v[116:117]
    v_mfma_f32_16x16x32_bf16 v[46:49], v[138:141], v[126:129], v[46:49]
    v_cvt_pk_bf16_f32 v132, v6, v7
    v_cvt_pk_bf16_f32 v133, v8, v9
    v_lshlrev_b32 v6, 16, v90
    v_lshlrev_b32 v7, 16, v91
    v_lshlrev_b32 v8, 16, v92
    v_lshlrev_b32 v9, 16, v93
    v_pk_mul_f32 v[6:7], v[6:7], v[98:99]
    v_pk_mul_f32 v[8:9], v[8:9], v[100:101]
    s_waitcnt lgkmcnt(0)
    v_mfma_f32_16x16x32_bf16 v[30:33], v[142:145], v[130:133], v[30:33]
    v_cvt_pk_bf16_f32 v136, v6, v7
    v_cvt_pk_bf16_f32 v137, v8, v9
    v_and_b32 v6, 0xffff0000, v54
    v_and_b32 v7, 0xffff0000, v58
    v_and_b32 v8, 0xffff0000, v55
    v_and_b32 v9, 0xffff0000, v59
    v_pk_mul_f32 v[6:7], v[6:7], v[102:103]
    v_pk_mul_f32 v[8:9], v[8:9], v[102:103]
    v_mfma_f32_16x16x32_bf16 v[38:41], v[146:149], v[130:133], v[38:41]
    v_cvt_pk_bf16_f32 v118, v6, v7
    v_cvt_pk_bf16_f32 v122, v8, v9
    v_and_b32 v6, 0xffff0000, v56
    v_and_b32 v7, 0xffff0000, v60
    v_and_b32 v8, 0xffff0000, v57
    v_and_b32 v9, 0xffff0000, v61
    v_pk_mul_f32 v[6:7], v[6:7], v[102:103]
    v_pk_mul_f32 v[8:9], v[8:9], v[110:111]
    v_mfma_f32_16x16x32_bf16 v[46:49], v[150:153], v[130:133], v[46:49]
    v_cvt_pk_bf16_f32 v126, v6, v7
    v_cvt_pk_bf16_f32 v130, v8, v9
    v_and_b32 v6, 0xffff0000, v86
    v_and_b32 v7, 0xffff0000, v87
    v_and_b32 v8, 0xffff0000, v62
    v_and_b32 v9, 0xffff0000, v66
    v_pk_mul_f32 v[6:7], v[6:7], v[94:95]
    v_pk_mul_f32 v[8:9], v[8:9], v[104:105]
    v_add_u32 v166, v154, v0
    buffer_load_dwordx4 v[54:57], v166, s[44:47], 0 idxen sc1
    buffer_load_dword v86, v166, s[48:51], 0 idxen sc1
    v_add_u32 v167, v155, v0
    buffer_load_dwordx4 v[58:61], v167, s[44:47], 0 idxen sc1
    buffer_load_dword v87, v167, s[48:51], 0 idxen sc1
    ds_read_b32 v154, v5 offset:1408
    ds_read_b32 v155, v5 offset:1424
    v_mfma_f32_16x16x32_bf16 v[22:25], v[138:141], v[134:137], v[22:25]
    v_cvt_pk_bf16_f32 v134, v6, v7
    v_cvt_pk_bf16_f32 v119, v8, v9
    v_and_b32 v6, 0xffff0000, v63
    v_and_b32 v7, 0xffff0000, v67
    v_and_b32 v8, 0xffff0000, v64
    v_and_b32 v9, 0xffff0000, v68
    v_pk_mul_f32 v[6:7], v[6:7], v[104:105]
    v_pk_mul_f32 v[8:9], v[8:9], v[104:105]
    v_mfma_f32_16x16x16_bf16 v[106:109], v[164:165], v[16:17], 0
    v_cvt_pk_bf16_f32 v123, v6, v7
    v_cvt_pk_bf16_f32 v127, v8, v9
    v_and_b32 v6, 0xffff0000, v65
    v_and_b32 v7, 0xffff0000, v69
    v_and_b32 v8, 0xffff0000, v88
    v_and_b32 v9, 0xffff0000, v89
    v_pk_mul_f32 v[6:7], v[6:7], v[112:113]
    v_pk_mul_f32 v[8:9], v[8:9], v[96:97]
    v_add_u32 v166, v156, v0
    buffer_load_dwordx4 v[62:65], v166, s[44:47], 0 idxen sc1
    buffer_load_dword v88, v166, s[48:51], 0 idxen sc1
    v_add_u32 v167, v157, v0
    buffer_load_dwordx4 v[66:69], v167, s[44:47], 0 idxen sc1
    buffer_load_dword v89, v167, s[48:51], 0 idxen sc1
    v_mfma_f32_16x16x16_bf16 v[114:117], v[164:165], v[20:21], 0
    v_cvt_pk_bf16_f32 v131, v6, v7
    v_cvt_pk_bf16_f32 v135, v8, v9
    v_and_b32 v6, 0xffff0000, v70
    v_and_b32 v7, 0xffff0000, v74
    v_and_b32 v8, 0xffff0000, v78
    v_and_b32 v9, 0xffff0000, v82
    v_pk_mul_f32 v[6:7], v[6:7], v[106:107]
    v_pk_mul_f32 v[8:9], v[8:9], v[108:109]
    v_mfma_f32_16x16x16_bf16 v[98:101], v[164:165], v[12:13], 0
    v_cvt_pk_bf16_f32 v120, v6, v7
    v_cvt_pk_bf16_f32 v121, v8, v9
    v_and_b32 v6, 0xffff0000, v71
    v_and_b32 v7, 0xffff0000, v75
    v_and_b32 v8, 0xffff0000, v79
    v_and_b32 v9, 0xffff0000, v83
    v_pk_mul_f32 v[6:7], v[6:7], v[106:107]
    v_pk_mul_f32 v[8:9], v[8:9], v[108:109]
    s_waitcnt lgkmcnt(0)
    v_or_b32 v166, v154, v155
    v_cmp_gt_i32 vcc, 0, v166
    s_cbranch_vccnz K2_RARE1
    v_add_u32 v154, v154, v2
    v_add_u32 v155, v155, v2
    ds_read_b64 v[162:163], v154
    ds_read_b64 v[164:165], v155
K2_RARE_BACK1:
    v_mfma_f32_16x16x32_bf16 v[34:37], v[138:141], v[118:121], v[34:37]
    v_cvt_pk_bf16_f32 v124, v6, v7
    v_cvt_pk_bf16_f32 v125, v8, v9
    v_and_b32 v6, 0xffff0000, v72
    v_and_b32 v7, 0xffff0000, v76
    v_and_b32 v8, 0xffff0000, v80
    v_and_b32 v9, 0xffff0000, v84
    v_pk_mul_f32 v[6:7], v[6:7], v[106:107]
    v_pk_mul_f32 v[8:9], v[8:9], v[108:109]
    v_mfma_f32_16x16x32_bf16 v[42:45], v[138:141], v[122:125], v[42:45]
    v_cvt_pk_bf16_f32 v128, v6, v7
    v_cvt_pk_bf16_f32 v129, v8, v9
    v_and_b32 v6, 0xffff0000, v73
    v_and_b32 v7, 0xffff0000, v77
    v_and_b32 v8, 0xffff0000, v81
    v_and_b32 v9, 0xffff0000, v85
    v_pk_mul_f32 v[6:7], v[6:7], v[114:115]
    v_pk_mul_f32 v[8:9], v[8:9], v[116:117]
    v_mfma_f32_16x16x32_bf16 v[50:53], v[138:141], v[126:129], v[50:53]
    v_cvt_pk_bf16_f32 v132, v6, v7
    v_cvt_pk_bf16_f32 v133, v8, v9
    v_and_b32 v6, 0xffff0000, v90
    v_and_b32 v7, 0xffff0000, v91
    v_and_b32 v8, 0xffff0000, v92
    v_and_b32 v9, 0xffff0000, v93
    v_pk_mul_f32 v[6:7], v[6:7], v[98:99]
    v_pk_mul_f32 v[8:9], v[8:9], v[100:101]
    v_add_u32 v166, v158, v0
    buffer_load_dwordx4 v[70:73], v166, s[44:47], 0 idxen sc1
    buffer_load_dword v90, v166, s[48:51], 0 idxen sc1
    s_waitcnt lgkmcnt(0)
    v_mfma_f32_16x16x16_bf16 v[102:105], v[162:163], v[14:15], 0
    v_add_u32 v167, v159, v0
    buffer_load_dwordx4 v[74:77], v167, s[44:47], 0 idxen sc1
    buffer_load_dword v91, v167, s[48:51], 0 idxen sc1
    v_mfma_f32_16x16x16_bf16 v[110:113], v[162:163], v[18:19], 0
    v_add_u32 v166, v160, v0
    buffer_load_dwordx4 v[78:81], v166, s[44:47], 0 idxen sc1
    buffer_load_dword v92, v166, s[48:51], 0 idxen sc1
    v_mfma_f32_16x16x16_bf16 v[94:97], v[162:163], v[10:11], 0
    v_add_u32 v167, v161, v0
    buffer_load_dwordx4 v[82:85], v167, s[44:47], 0 idxen sc1
    buffer_load_dword v93, v167, s[48:51], 0 idxen sc1
    v_add_u32 v5, 128, v5
    s_add_u32 s53, s53, 1
    s_sub_u32 s58, s58, 1
    s_cmp_lg_u32 s58, 0
    s_cbranch_scc1 K2_TILE
    s_cmp_eq_u32 s54, 0
    s_cbranch_scc1 K2_FLUSH
K2_HALF:
    s_setprio 0
    s_waitcnt vmcnt(0)
    v_mfma_f32_16x16x32_bf16 v[34:37], v[142:145], v[130:133], v[34:37]
    v_cvt_pk_bf16_f32 v136, v6, v7
    v_cvt_pk_bf16_f32 v137, v8, v9
    v_lshlrev_b32 v6, 16, v54
    v_lshlrev_b32 v7, 16, v58
    v_lshlrev_b32 v8, 16, v62
    v_lshlrev_b32 v9, 16, v66
    v_pk_mul_f32 v[6:7], v[6:7], v[102:103]
    v_pk_mul_f32 v[8:9], v[8:9], v[104:105]
    v_mfma_f32_16x16x32_bf16 v[42:45], v[146:149], v[130:133], v[42:45]
    v_cvt_pk_bf16_f32 v118, v6, v7
    v_cvt_pk_bf16_f32 v119, v8, v9
    v_lshlrev_b32 v6, 16, v55
    v_lshlrev_b32 v7, 16, v59
    v_lshlrev_b32 v8, 16, v63
    v_lshlrev_b32 v9, 16, v67
    v_pk_mul_f32 v[6:7], v[6:7], v[102:103]
    v_pk_mul_f32 v[8:9], v[8:9], v[104:105]
    v_mfma_f32_16x16x32_bf16 v[50:53], v[150:153], v[130:133], v[50:53]
    v_cvt_pk_bf16_f32 v122, v6, v7
    v_cvt_pk_bf16_f32 v123, v8, v9
    v_lshlrev_b32 v6, 16, v56
    v_lshlrev_b32 v7, 16, v60
    v_lshlrev_b32 v8, 16, v64
    v_lshlrev_b32 v9, 16, v68
    v_pk_mul_f32 v[6:7], v[6:7], v[102:103]
    v_pk_mul_f32 v[8:9], v[8:9], v[104:105]
    v_mfma_f32_16x16x32_bf16 v[26:29], v[138:141], v[134:137], v[26:29]
    v_cvt_pk_bf16_f32 v126, v6, v7
    v_cvt_pk_bf16_f32 v127, v8, v9
    v_lshlrev_b32 v6, 16, v57
    v_lshlrev_b32 v7, 16, v61
    v_lshlrev_b32 v8, 16, v65
    v_lshlrev_b32 v9, 16, v69
    v_pk_mul_f32 v[6:7], v[6:7], v[110:111]
    v_pk_mul_f32 v[8:9], v[8:9], v[112:113]
    v_mfma_f32_16x16x16_bf16 v[102:105], v[162:163], v[16:17], 0
    ds_read_b128 v[138:141], v4 offset:2560
    ds_read_b128 v[142:145], v4 offset:3200
    ds_read_b128 v[146:149], v4 offset:3840
    ds_read_b128 v[150:153], v4 offset:4480
    v_cvt_pk_bf16_f32 v130, v6, v7
    v_cvt_pk_bf16_f32 v131, v8, v9
    v_lshlrev_b32 v6, 16, v86
    v_lshlrev_b32 v7, 16, v87
    v_lshlrev_b32 v8, 16, v88
    v_lshlrev_b32 v9, 16, v89
    v_pk_mul_f32 v[6:7], v[6:7], v[94:95]
    v_pk_mul_f32 v[8:9], v[8:9], v[96:97]
    v_cvt_pk_bf16_f32 v134, v6, v7
    v_cvt_pk_bf16_f32 v135, v8, v9
    v_mov_b32 v120, 0
    v_mov_b32 v121, 0
    v_mov_b32 v124, 0
    v_mov_b32 v125, 0
    v_mov_b32 v128, 0
    v_mov_b32 v129, 0
    v_mov_b32 v132, 0
    v_mov_b32 v133, 0
    v_mov_b32 v136, 0
    v_mov_b32 v137, 0
    s_waitcnt lgkmcnt(0)
    v_mfma_f32_16x16x16_bf16 v[110:113], v[162:163], v[20:21], 0
    v_pk_lshlrev_b16 v138, v1, v138
    v_pk_lshlrev_b16 v139, v1, v139
    v_pk_lshlrev_b16 v140, v1, v140
    v_pk_lshlrev_b16 v141, v1, v141
    v_pk_ashrrev_i16 v138, 15, v138 op_sel_hi:[0,1]
    v_pk_ashrrev_i16 v139, 15, v139 op_sel_hi:[0,1]
    v_pk_ashrrev_i16 v140, 15, v140 op_sel_hi:[0,1]
    v_pk_ashrrev_i16 v141, 15, v141 op_sel_hi:[0,1]
    v_mfma_f32_16x16x16_bf16 v[94:97], v[162:163], v[12:13], 0
    v_and_b32 v142, v138, v142
    v_and_b32 v143, v139, v143
    v_and_b32 v144, v140, v144
    v_and_b32 v145, v141, v145
    v_and_b32 v146, v138, v146
    v_and_b32 v147, v139, v147
    v_and_b32 v148, v140, v148
    v_and_b32 v149, v141, v149
    v_and_b32 v150, v138, v150
    v_and_b32 v151, v139, v151
    v_and_b32 v152, v140, v152
    v_and_b32 v153, v141, v153
    v_and_b32 v138, 0x3f803f80, v138
    v_and_b32 v139, 0x3f803f80, v139
    v_and_b32 v140, 0x3f803f80, v140
    v_and_b32 v141, 0x3f803f80, v141
    s_nop 1
    v_mfma_f32_16x16x32_bf16 v[30:33], v[138:141], v[118:121], v[30:33]
    v_mfma_f32_16x16x32_bf16 v[38:41], v[138:141], v[122:125], v[38:41]
    v_mfma_f32_16x16x32_bf16 v[46:49], v[138:141], v[126:129], v[46:49]
    v_mfma_f32_16x16x32_bf16 v[30:33], v[142:145], v[130:133], v[30:33]
    v_and_b32 v6, 0xffff0000, v54
    v_and_b32 v7, 0xffff0000, v58
    v_and_b32 v8, 0xffff0000, v55
    v_and_b32 v9, 0xffff0000, v59
    v_pk_mul_f32 v[6:7], v[6:7], v[102:103]
    v_pk_mul_f32 v[8:9], v[8:9], v[102:103]
    v_mfma_f32_16x16x32_bf16 v[38:41], v[146:149], v[130:133], v[38:41]
    v_mfma_f32_16x16x32_bf16 v[46:49], v[150:153], v[130:133], v[46:49]
    v_cvt_pk_bf16_f32 v118, v6, v7
    v_cvt_pk_bf16_f32 v122, v8, v9
    v_and_b32 v6, 0xffff0000, v56
    v_and_b32 v7, 0xffff0000, v60
    v_and_b32 v8, 0xffff0000, v57
    v_and_b32 v9, 0xffff0000, v61
    v_pk_mul_f32 v[6:7], v[6:7], v[102:103]
    v_pk_mul_f32 v[8:9], v[8:9], v[110:111]
    v_mfma_f32_16x16x32_bf16 v[22:25], v[138:141], v[134:137], v[22:25]
    v_cvt_pk_bf16_f32 v126, v6, v7
    v_cvt_pk_bf16_f32 v130, v8, v9
    v_and_b32 v6, 0xffff0000, v86
    v_and_b32 v7, 0xffff0000, v87
    v_and_b32 v8, 0xffff0000, v62
    v_and_b32 v9, 0xffff0000, v66
    v_pk_mul_f32 v[6:7], v[6:7], v[94:95]
    v_pk_mul_f32 v[8:9], v[8:9], v[104:105]
    v_cvt_pk_bf16_f32 v134, v6, v7
    v_cvt_pk_bf16_f32 v119, v8, v9
    v_and_b32 v6, 0xffff0000, v63
    v_and_b32 v7, 0xffff0000, v67
    v_and_b32 v8, 0xffff0000, v64
    v_and_b32 v9, 0xffff0000, v68
    v_pk_mul_f32 v[6:7], v[6:7], v[104:105]
    v_pk_mul_f32 v[8:9], v[8:9], v[104:105]
    v_cvt_pk_bf16_f32 v123, v6, v7
    v_cvt_pk_bf16_f32 v127, v8, v9
    v_and_b32 v6, 0xffff0000, v65
    v_and_b32 v7, 0xffff0000, v69
    v_and_b32 v8, 0xffff0000, v88
    v_and_b32 v9, 0xffff0000, v89
    v_pk_mul_f32 v[6:7], v[6:7], v[112:113]
    v_pk_mul_f32 v[8:9], v[8:9], v[96:97]
    v_cvt_pk_bf16_f32 v131, v6, v7
    v_cvt_pk_bf16_f32 v135, v8, v9
    s_nop 1
    v_mfma_f32_16x16x32_bf16 v[34:37], v[138:141], v[118:121], v[34:37]
    v_mfma_f32_16x16x32_bf16 v[42:45], v[138:141], v[122:125], v[42:45]
    v_mfma_f32_16x16x32_bf16 v[50:53], v[138:141], v[126:129], v[50:53]
    v_mfma_f32_16x16x32_bf16 v[34:37], v[142:145], v[130:133], v[34:37]
    v_mfma_f32_16x16x32_bf16 v[42:45], v[146:149], v[130:133], v[42:45]
    v_mfma_f32_16x16x32_bf16 v[50:53], v[150:153], v[130:133], v[50:53]
    v_mfma_f32_16x16x32_bf16 v[26:29], v[138:141], v[134:137], v[26:29]
    s_waitcnt vmcnt(0) lgkmcnt(0)
    s_branch K2_TILES_DONE
K2_FLUSH:
    v_cvt_pk_bf16_f32 v136, v6, v7
    v_cvt_pk_bf16_f32 v137, v8, v9
    v_mfma_f32_16x16x32_bf16 v[34:37], v[142:145], v[130:133], v[34:37]
    v_mfma_f32_16x16x32_bf16 v[42:45], v[146:149], v[130:133], v[42:45]
    v_mfma_f32_16x16x32_bf16 v[50:53], v[150:153], v[130:133], v[50:53]
    v_mfma_f32_16x16x32_bf16 v[26:29], v[138:141], v[134:137], v[26:29]
    s_waitcnt vmcnt(0) lgkmcnt(0)
    s_branch K2_TILES_DONE
K2_NOTILES:
K2_TILES_DONE:
    s_add_u32 s52, s52, 256
    s_cmp_lt_u32 s52, s19
    s_cbranch_scc1 K2_MORE
K2_EPI:
    s_cmp_lg_u32 s60, 0
    s_cbranch_scc1 K2_RESDONEB
    s_mov_b32 s60, 1
    v_mbcnt_lo_u32_b32 v166, -1, 0
    v_mbcnt_hi_u32_b32 v166, -1, v166
    v_and_b32 v167, 3, v166
    v_lshlrev_b32 v167, 4, v167
    v_lshrrev_b32 v166, 2, v166
    v_lshl_add_u32 v167, v166, 8, v167
    s_lshl_b32 s61, s15, 10
    s_lshl_b32 s62, s13, 6
    s_add_u32 s61, s61, s62
    s_lshl_b32 s62, s3, 12
    s_add_u32 s62, s62, 79872
    s_mov_b32 m0, s62
    s_add_u32 s62, s62, 1024
    buffer_load_dwordx4 v167, s[32:35], s61 offen  lds
    s_add_u32 s61, s61, 4096
    s_mov_b32 m0, s62
    s_add_u32 s62, s62, 1024
    buffer_load_dwordx4 v167, s[32:35], s61 offen  lds
    s_add_u32 s61, s61, 4096
    s_mov_b32 m0, s62
    s_add_u32 s62, s62, 1024
    buffer_load_dwordx4 v167, s[32:35], s61 offen  lds
    s_add_u32 s61, s61, 4096
    s_mov_b32 m0, s62
    s_add_u32 s62, s62, 1024
    buffer_load_dwordx4 v167, s[32:35], s61 offen  lds
    s_add_u32 s61, s61, 4096
K2_RESDONEB:
    s_waitcnt vmcnt(0)
    v_mbcnt_lo_u32_b32 v166, -1, 0
    v_mbcnt_hi_u32_b32 v166, -1, v166
    s_lshl_b32 s62, s97, 12
    s_add_u32 s62, s62, 79872
    v_lshrrev_b32 v167, 4, v166
    v_lshlrev_b32 v167, 10, v167
    v_lshl_add_u32 v167, v0, 2, v167
    v_add_u32 v167, s62, v167
    ds_read_b32 v54, v167 offset:0
    ds_read_b32 v55, v167 offset:64
    ds_read_b32 v56, v167 offset:128
    ds_read_b32 v57, v167 offset:192
    ds_read_b32 v58, v167 offset:256
    ds_read_b32 v59, v167 offset:320
    ds_read_b32 v60, v167 offset:384
    ds_read_b32 v61, v167 offset:448
    ds_read_b32 v62, v167 offset:512
    ds_read_b32 v63, v167 offset:576
    ds_read_b32 v64, v167 offset:640
    ds_read_b32 v65, v167 offset:704
    ds_read_b32 v66, v167 offset:768
    ds_read_b32 v67, v167 offset:832
    ds_read_b32 v68, v167 offset:896
    ds_read_b32 v69, v167 offset:960
    s_waitcnt lgkmcnt(0)
    v_lshlrev_b32 v6, 16, v54
    v_and_b32 v7, 0xffff0000, v54
    v_add_f32 v6, v6, v22
    v_add_f32 v7, v7, v26
    v_cvt_pk_bf16_f32 v54, v6, v7
    ds_write_b32 v167, v54 offset:0
    v_lshlrev_b32 v6, 16, v55
    v_and_b32 v7, 0xffff0000, v55
    v_add_f32 v6, v6, v30
    v_add_f32 v7, v7, v34
    v_cvt_pk_bf16_f32 v55, v6, v7
    ds_write_b32 v167, v55 offset:64
    v_lshlrev_b32 v6, 16, v56
    v_and_b32 v7, 0xffff0000, v56
    v_add_f32 v6, v6, v38
    v_add_f32 v7, v7, v42
    v_cvt_pk_bf16_f32 v56, v6, v7
    ds_write_b32 v167, v56 offset:128
    v_lshlrev_b32 v6, 16, v57
    v_and_b32 v7, 0xffff0000, v57
    v_add_f32 v6, v6, v46
    v_add_f32 v7, v7, v50
    v_cvt_pk_bf16_f32 v57, v6, v7
    ds_write_b32 v167, v57 offset:192
    v_lshlrev_b32 v6, 16, v58
    v_and_b32 v7, 0xffff0000, v58
    v_add_f32 v6, v6, v23
    v_add_f32 v7, v7, v27
    v_cvt_pk_bf16_f32 v58, v6, v7
    ds_write_b32 v167, v58 offset:256
    v_lshlrev_b32 v6, 16, v59
    v_and_b32 v7, 0xffff0000, v59
    v_add_f32 v6, v6, v31
    v_add_f32 v7, v7, v35
    v_cvt_pk_bf16_f32 v59, v6, v7
    ds_write_b32 v167, v59 offset:320
    v_lshlrev_b32 v6, 16, v60
    v_and_b32 v7, 0xffff0000, v60
    v_add_f32 v6, v6, v39
    v_add_f32 v7, v7, v43
    v_cvt_pk_bf16_f32 v60, v6, v7
    ds_write_b32 v167, v60 offset:384
    v_lshlrev_b32 v6, 16, v61
    v_and_b32 v7, 0xffff0000, v61
    v_add_f32 v6, v6, v47
    v_add_f32 v7, v7, v51
    v_cvt_pk_bf16_f32 v61, v6, v7
    ds_write_b32 v167, v61 offset:448
    v_lshlrev_b32 v6, 16, v62
    v_and_b32 v7, 0xffff0000, v62
    v_add_f32 v6, v6, v24
    v_add_f32 v7, v7, v28
    v_cvt_pk_bf16_f32 v62, v6, v7
    ds_write_b32 v167, v62 offset:512
    v_lshlrev_b32 v6, 16, v63
    v_and_b32 v7, 0xffff0000, v63
    v_add_f32 v6, v6, v32
    v_add_f32 v7, v7, v36
    v_cvt_pk_bf16_f32 v63, v6, v7
    ds_write_b32 v167, v63 offset:576
    v_lshlrev_b32 v6, 16, v64
    v_and_b32 v7, 0xffff0000, v64
    v_add_f32 v6, v6, v40
    v_add_f32 v7, v7, v44
    v_cvt_pk_bf16_f32 v64, v6, v7
    ds_write_b32 v167, v64 offset:640
    v_lshlrev_b32 v6, 16, v65
    v_and_b32 v7, 0xffff0000, v65
    v_add_f32 v6, v6, v48
    v_add_f32 v7, v7, v52
    v_cvt_pk_bf16_f32 v65, v6, v7
    ds_write_b32 v167, v65 offset:704
    v_lshlrev_b32 v6, 16, v66
    v_and_b32 v7, 0xffff0000, v66
    v_add_f32 v6, v6, v25
    v_add_f32 v7, v7, v29
    v_cvt_pk_bf16_f32 v66, v6, v7
    ds_write_b32 v167, v66 offset:768
    v_lshlrev_b32 v6, 16, v67
    v_and_b32 v7, 0xffff0000, v67
    v_add_f32 v6, v6, v33
    v_add_f32 v7, v7, v37
    v_cvt_pk_bf16_f32 v67, v6, v7
    ds_write_b32 v167, v67 offset:832
    v_lshlrev_b32 v6, 16, v68
    v_and_b32 v7, 0xffff0000, v68
    v_add_f32 v6, v6, v41
    v_add_f32 v7, v7, v45
    v_cvt_pk_bf16_f32 v68, v6, v7
    ds_write_b32 v167, v68 offset:896
    v_lshlrev_b32 v6, 16, v69
    v_and_b32 v7, 0xffff0000, v69
    v_add_f32 v6, v6, v49
    v_add_f32 v7, v7, v53
    v_cvt_pk_bf16_f32 v69, v6, v7
    ds_write_b32 v167, v69 offset:960
    v_lshlrev_b32 v6, 4, v166
    v_add_u32 v6, s62, v6
    ds_read_b128 v[118:121], v6 offset:0
    ds_read_b128 v[122:125], v6 offset:1024
    ds_read_b128 v[126:129], v6 offset:2048
    ds_read_b128 v[130:133], v6 offset:3072
    v_lshrrev_b32 v167, 4, v166
    v_lshlrev_b32 v7, 10, v167
    v_bfe_u32 v8, v166, 2, 2
    v_lshl_add_u32 v7, v8, 8, v7
    v_and_b32 v8, 3, v166
    v_lshl_add_u32 v7, v8, 4, v7
    s_lshl_b32 s61, s15, 10
    s_lshl_b32 s62, s13, 6
    s_add_u32 s61, s61, s62
    v_mov_b32 v8, 0x80000000
    v_add_u32 v9, 0, v167
    v_cmp_gt_u32 vcc, s16, v9
    s_nop 1
    v_cndmask_b32 v94, v8, v7, vcc
    v_add_u32 v9, 4, v167
    v_cmp_gt_u32 vcc, s16, v9
    s_nop 1
    v_cndmask_b32 v95, v8, v7, vcc
    v_add_u32 v9, 8, v167
    v_cmp_gt_u32 vcc, s16, v9
    s_nop 1
    v_cndmask_b32 v96, v8, v7, vcc
    v_add_u32 v9, 12, v167
    v_cmp_gt_u32 vcc, s16, v9
    s_nop 1
    v_cndmask_b32 v97, v8, v7, vcc
    s_waitcnt lgkmcnt(3)
    buffer_store_dwordx4 v[118:121], v94, s[36:39], s61 offen sc1
    s_add_u32 s61, s61, 4096
    s_waitcnt lgkmcnt(2)
    buffer_store_dwordx4 v[122:125], v95, s[36:39], s61 offen sc1
    s_add_u32 s61, s61, 4096
    s_waitcnt lgkmcnt(1)
    buffer_store_dwordx4 v[126:129], v96, s[36:39], s61 offen sc1
    s_add_u32 s61, s61, 4096
    s_waitcnt lgkmcnt(0)
    buffer_store_dwordx4 v[130:133], v97, s[36:39], s61 offen sc1
    s_add_u32 s61, s61, 4096
K2_END:
    s_endpgm
K2_MORE:
    v_mov_b32 v138, 0
    v_mov_b32 v139, 0
    v_mov_b32 v140, 0
    v_mov_b32 v141, 0
    v_mov_b32 v142, 0
    v_mov_b32 v143, 0
    v_mov_b32 v144, 0
    v_mov_b32 v145, 0
    v_mov_b32 v146, 0
    v_mov_b32 v147, 0
    v_mov_b32 v148, 0
    v_mov_b32 v149, 0
    v_mov_b32 v150, 0
    v_mov_b32 v151, 0
    v_mov_b32 v152, 0
    v_mov_b32 v153, 0
    v_mbcnt_lo_u32_b32 v166, -1, 0
    v_mbcnt_hi_u32_b32 v166, -1, v166
    v_mul_u32_u24 v6, 3072, v166
    s_lshl_b32 s17, s14, 2
    buffer_load_dword v7, v6, s[20:23], s17 offen sc1
    s_waitcnt vmcnt(0)
    v_lshrrev_b32 v154, 16, v7
    v_and_b32 v155, 0xffff, v7
    v_mov_b32 v156, v154
    s_nop 1
    v_add_u32_dpp v156, v156, v156 row_shr:1 row_mask:0xf bank_mask:0xf
    s_nop 1
    v_add_u32_dpp v156, v156, v156 row_shr:2 row_mask:0xf bank_mask:0xf
    s_nop 1
    v_add_u32_dpp v156, v156, v156 row_shr:4 row_mask:0xf bank_mask:0xf
    s_nop 1
    v_add_u32_dpp v156, v156, v156 row_shr:8 row_mask:0xf bank_mask:0xf
    s_nop 1
    v_add_u32_dpp v156, v156, v156 row_bcast:15 row_mask:0xa bank_mask:0xf
    s_nop 1
    v_add_u32_dpp v156, v156, v156 row_bcast:31 row_mask:0xc bank_mask:0xf
    s_nop 1
    v_sub_u32 v156, v156, v154
    v_lshl_add_u32 v157, v166, 12, v155
    s_branch K2_CHUNK
K2_RARE0:
    v_max_i32 v166, 0, v8
    v_max_i32 v167, 0, v9
    v_add_u32 v166, v166, v2
    v_add_u32 v167, v167, v2
    ds_read_b64 v[162:163], v166
    ds_read_b64 v[164:165], v167
    s_waitcnt lgkmcnt(0)
    v_cmp_gt_i32 vcc, 0, v8
    v_add_u32 v166, 47104, v8
    v_add_u32 v166, v166, v2
    s_and_saveexec_b64 s[62:63], vcc
    s_cbranch_execz K2_RSK0_0
    buffer_load_dwordx2 v[162:163], v166, s[28:31], 0 offen sc1
    s_waitcnt vmcnt(0)
K2_RSK0_0:
    s_mov_b64 exec, s[62:63]
    v_cmp_gt_i32 vcc, 0, v9
    v_add_u32 v166, 47104, v9
    v_add_u32 v166, v166, v2
    s_and_saveexec_b64 s[62:63], vcc
    s_cbranch_execz K2_RSK0_1
    buffer_load_dwordx2 v[164:165], v166, s[28:31], 0 offen sc1
    s_waitcnt vmcnt(0)
K2_RSK0_1:
    s_mov_b64 exec, s[62:63]
    s_branch K2_RARE_BACK0
K2_RARE1:
    v_max_i32 v166, 0, v154
    v_max_i32 v167, 0, v155
    v_add_u32 v166, v166, v2
    v_add_u32 v167, v167, v2
    ds_read_b64 v[162:163], v166
    ds_read_b64 v[164:165], v167
    s_waitcnt lgkmcnt(0)
    v_cmp_gt_i32 vcc, 0, v154
    v_add_u32 v166, 47104, v154
    v_add_u32 v166, v166, v2
    s_and_saveexec_b64 s[62:63], vcc
    s_cbranch_execz K2_RSK1_0
    buffer_load_dwordx2 v[162:163], v166, s[28:31], 0 offen sc1
    s_waitcnt vmcnt(0)
K2_RSK1_0:
    s_mov_b64 exec, s[62:63]
    v_cmp_gt_i32 vcc, 0, v155
    v_add_u32 v166, 47104, v155
    v_add_u32 v166, v166, v2
    s_and_saveexec_b64 s[62:63], vcc
    s_cbranch_execz K2_RSK1_1
    buffer_load_dwordx2 v[164:165], v166, s[28:31], 0 offen sc1
    s_waitcnt vmcnt(0)
K2_RSK1_1:
    s_mov_b64 exec, s[62:63]
    s_branch K2_RARE_BACK1
K1_BIN:
    v_lshrrev_b32 v1, 6, v0
    v_and_b32 v2, 63, v0
    s_nop 0
    v_readfirstlane_b32 s3, v1
    s_waitcnt lgkmcnt(0)
    s_mov_b32 s28, s8
    s_mov_b32 s29, s9
    s_mov_b32 s30, 640000
    s_mov_b32 s31, 0x00020000
    s_mov_b32 s32, s10
    s_mov_b32 s33, s11
    s_mov_b32 s34, 640000
    s_mov_b32 s35, 0x00020000
    s_mov_b32 s36, s6
    s_mov_b32 s37, s7
    s_mov_b32 s38, 60000
    s_mov_b32 s39, 0x00020000
    s_add_u32 s40, s20, 0xca0000
    s_addc_u32 s41, s21, 0
    s_mov_b32 s42, 144384
    s_mov_b32 s43, 0x00020000
    s_add_u32 s44, s20, 0xd00000
    s_addc_u32 s45, s21, 0
    s_mov_b32 s46, 3080192
    s_mov_b32 s47, 0x00020000
    s_mul_i32 s24, s91, 3405
    s_sub_u32 s25, 160000, s24
    s_min_u32 s25, s25, 3405
    v_lshlrev_b32 v1, 2, v0
    v_mov_b32 v3, 0
    ds_write_b32 v1, v3
    s_mov_b32 s64, s12
    s_mov_b32 s65, s13
    s_mov_b32 s66, 32
    s_mov_b32 s67, 0x00020000
    s_add_u32 s84, s20, 0xc80000
    s_addc_u32 s85, s21, 0
    s_mov_b32 s86, 65536
    s_mov_b32 s87, 0x00020000
    v_and_b32 v82, 15, v0
    v_lshlrev_b32 v83, 1, v82
    buffer_load_ushort v84, v83, s[64:67], 0 offen
    s_cmp_lg_u32 s91, 0
    s_cbranch_scc1 K1_NOWB1
    s_mov_b32 s64, s18
    s_mov_b32 s65, s19
    s_mov_b32 s66, 12288
    s_mov_b32 s67, 0x00020000
    v_lshrrev_b32 v90, 4, v2
    v_and_b32 v91, 15, v2
    v_mul_u32_u24 v90, 3072, v90
    v_lshl_add_u32 v90, v91, 2, v90
    s_and_b32 s61, s3, 3
    s_lshr_b32 s62, s3, 2
    s_lshl_b32 s63, s61, 6
    s_lshl_b32 s68, s62, 8
    s_add_u32 s63, s63, s68
    buffer_load_dword v92, v90, s[64:67], s63 offen offset:0
    buffer_load_dword v93, v90, s[64:67], s63 offen offset:768
    buffer_load_dword v94, v90, s[64:67], s63 offen offset:1536
    buffer_load_dword v95, v90, s[64:67], s63 offen offset:2304
K1_NOWB1:
    v_lshlrev_b32 v5, 4, v2
    s_add_u32 s26, s3, 0
    s_lshl_b32 s26, s26, 10
    s_add_u32 s27, s26, 69632
    s_mov_b32 m0, s27
    s_nop 0
    buffer_load_dwordx4 v5, s[36:39], s26 offen lds
    s_add_u32 s26, s3, 12
    s_lshl_b32 s26, s26, 10
    s_add_u32 s27, s26, 69632
    s_mov_b32 m0, s27
    s_nop 0
    buffer_load_dwordx4 v5, s[36:39], s26 offen lds
    s_add_u32 s26, s3, 24
    s_lshl_b32 s26, s26, 10
    s_add_u32 s27, s26, 69632
    s_mov_b32 m0, s27
    s_nop 0
    buffer_load_dwordx4 v5, s[36:39], s26 offen lds
    s_add_u32 s26, s3, 36
    s_lshl_b32 s26, s26, 10
    s_add_u32 s27, s26, 69632
    s_mov_b32 m0, s27
    s_nop 0
    buffer_load_dwordx4 v5, s[36:39], s26 offen lds
    s_cmp_ge_u32 s3, 11
    s_cbranch_scc1 K1_POSDONE
    s_add_u32 s26, s3, 48
    s_lshl_b32 s26, s26, 10
    s_add_u32 s27, s26, 69632
    s_mov_b32 m0, s27
    s_nop 0
    buffer_load_dwordx4 v5, s[36:39], s26 offen lds
K1_POSDONE:
    v_add_u32 v4, s24, v0
    v_lshlrev_b32 v4, 2, v4
    s_mov_b32 s26, 0
    buffer_load_dword v10, v4, s[28:31], s26 offen
    buffer_load_dword v15, v4, s[32:35], s26 offen
    s_mov_b32 s26, 3072
    buffer_load_dword v11, v4, s[28:31], s26 offen
    buffer_load_dword v16, v4, s[32:35], s26 offen
    s_mov_b32 s26, 6144
    buffer_load_dword v12, v4, s[28:31], s26 offen
    buffer_load_dword v17, v4, s[32:35], s26 offen
    s_mov_b32 s26, 9216
    buffer_load_dword v13, v4, s[28:31], s26 offen
    buffer_load_dword v18, v4, s[32:35], s26 offen
    s_mov_b32 s26, 12288
    buffer_load_dword v14, v4, s[28:31], s26 offen
    buffer_load_dword v19, v4, s[32:35], s26 offen
    v_add_u32 v5, 0, v0
    v_cmp_gt_u32 s[50:51], s25, v5
    v_add_u32 v5, 768, v0
    v_cmp_gt_u32 s[52:53], s25, v5
    v_add_u32 v5, 1536, v0
    v_cmp_gt_u32 s[54:55], s25, v5
    v_add_u32 v5, 2304, v0
    v_cmp_gt_u32 s[56:57], s25, v5
    v_add_u32 v5, 3072, v0
    v_cmp_gt_u32 s[58:59], s25, v5
    v_mov_b32 v6, 0xffff0000
    s_mov_b32 s92, s96
    s_mov_b32 s93, s97
    s_mov_b32 s94, 256
    s_mov_b32 s95, 0x00020000
    s_or_b32 s68, s91, s3
    s_cmp_lg_u32 s68, 0
    s_cbranch_scc1 K1_NONONCE
    s_memrealtime s[98:99]
    s_waitcnt lgkmcnt(0)
    s_or_b32 s98, s98, 1
    v_mov_b32 v166, s98
    v_mov_b32 v165, 0
    s_mov_b64 exec, 1
    buffer_store_dword v166, v165, s[92:95], 0 offen sc1
    s_mov_b64 exec, -1
K1_NONONCE:
    v_lshrrev_b32 v85, 4, v0
    s_mul_i32 s61, s91, 48
    v_add_u32 v85, s61, v85
    v_add_u32 v86, 0x38c0, v85
    v_lshlrev_b32 v86, 16, v86
    v_mul_f32 v87, 0x40490fdb, v86
    v_cvt_pk_bf16_f32 v87, v87, v87
    v_and_b32 v87, v6, v87
    v_mul_f32 v87, 0x3e4ccccd, v87
    v_cvt_pk_bf16_f32 v87, v87, v87
    v_and_b32 v87, v6, v87
    v_mul_f32 v87, 0x3e22f983, v87
    v_cos_f32 v87, v87
    v_rcp_f32 v88, v86
    v_cvt_pk_bf16_f32 v87, v87, v87
    v_and_b32 v87, v6, v87
    v_add_f32 v87, 1.0, v87
    v_cvt_pk_bf16_f32 v87, v87, v87
    v_and_b32 v87, v6, v87
    v_mul_f32 v87, 0.5, v87
    v_cmp_gt_u32 vcc, 0x40a00000, v86
    v_cmp_ne_u32 s[62:63], 0, v85
    s_and_b64 vcc, vcc, s[62:63]
    s_nop 1
    v_cndmask_b32 v87, 0, v87, vcc
    s_waitcnt vmcnt(14)
    v_lshlrev_b32 v84, 16, v84
    v_mul_f32 v84, v84, v86
    v_cvt_pk_bf16_f32 v84, v84, v84
    v_and_b32 v84, v6, v84
    v_mul_f32 v89, 0x3e22f983, v84
    v_mov_b32 v81, 0x3e22f983
    v_fma_f32 v80, v84, v81, -v89
    v_mov_b32 v81, 0x31dc9c88
    v_fma_f32 v80, v84, v81, v80
    v_fract_f32 v89, v89
    v_add_f32 v89, v89, v80
    v_sin_f32 v89, v89
    s_nop 0
    v_cvt_pk_bf16_f32 v89, v89, v89
    v_and_b32 v89, v6, v89
    v_mul_f32 v89, v89, v88
    v_cvt_pk_bf16_f32 v89, v89, v89
    v_and_b32 v89, v6, v89
    v_mul_f32 v89, v89, v87
    v_cvt_pk_bf16_f32 v89, v89, v89
    s_nop 1
    v_mov_b32_dpp v88, v89 quad_perm:[1,0,3,2] row_mask:0xf bank_mask:0xf
    v_and_b32 v89, 0xffff, v89
    v_and_b32 v88, v6, v88
    v_or_b32 v89, v89, v88
    v_lshlrev_b32 v85, 5, v85
    v_add_u32 v85, v85, v83
    s_waitcnt vmcnt(10) lgkmcnt(0)
    s_barrier
    s_mov_b32 s62, 0x55555555
    s_mov_b32 s63, 0x55555555
    s_mov_b64 exec, s[62:63]
    buffer_store_dword v89, v85, s[84:87], 0 offen sc1
    s_mov_b64 exec, -1
    s_cmp_lg_u32 s91, 0
    s_cbranch_scc1 K1_NOWB2
    s_add_u32 s64, s20, 0xc90000
    s_addc_u32 s65, s21, 0
    s_mov_b32 s66, 12288
    s_mov_b32 s67, 0x00020000
    s_mov_b32 s62, 0x05040100
    s_mov_b32 s63, 0x07060302
    v_perm_b32 v96, v93, v92, s62
    v_perm_b32 v97, v95, v94, s62
    v_perm_b32 v98, v93, v92, s63
    v_perm_b32 v99, v95, v94, s63
    s_and_b32 s61, s3, 3
    s_lshr_b32 s62, s3, 2
    s_mul_i32 s61, s61, 3
    s_add_u32 s61, s61, s62
    s_lshl_b32 s61, s61, 10
    v_lshlrev_b32 v91, 4, v2
    buffer_store_dwordx4 v[96:99], v91, s[64:67], s61 offen sc1
K1_NOWB2:
    s_waitcnt vmcnt(9)
    v_mul_u32_u24 v5, 6, v10
    v_and_b32 v5, -4, v5
    v_add_u32 v5, 69632, v5
    ds_read2_b32 v[20:21], v5 offset0:0 offset1:1
    v_mul_u32_u24 v5, 6, v15
    v_and_b32 v5, -4, v5
    v_add_u32 v5, 69632, v5
    ds_read2_b32 v[30:31], v5 offset0:0 offset1:1
    s_waitcnt vmcnt(7)
    v_mul_u32_u24 v5, 6, v11
    v_and_b32 v5, -4, v5
    v_add_u32 v5, 69632, v5
    ds_read2_b32 v[22:23], v5 offset0:0 offset1:1
    v_mul_u32_u24 v5, 6, v16
    v_and_b32 v5, -4, v5
    v_add_u32 v5, 69632, v5
    ds_read2_b32 v[32:33], v5 offset0:0 offset1:1
    s_waitcnt vmcnt(5)
    v_mul_u32_u24 v5, 6, v12
    v_and_b32 v5, -4, v5
    v_add_u32 v5, 69632, v5
    ds_read2_b32 v[24:25], v5 offset0:0 offset1:1
    v_mul_u32_u24 v5, 6, v17
    v_and_b32 v5, -4, v5
    v_add_u32 v5, 69632, v5
    ds_read2_b32 v[34:35], v5 offset0:0 offset1:1
    s_waitcnt vmcnt(3)
    v_mul_u32_u24 v5, 6, v13
    v_and_b32 v5, -4, v5
    v_add_u32 v5, 69632, v5
    ds_read2_b32 v[26:27], v5 offset0:0 offset1:1
    v_mul_u32_u24 v5, 6, v18
    v_and_b32 v5, -4, v5
    v_add_u32 v5, 69632, v5
    ds_read2_b32 v[36:37], v5 offset0:0 offset1:1
    s_waitcnt vmcnt(1)
    v_mul_u32_u24 v5, 6, v14
    v_and_b32 v5, -4, v5
    v_add_u32 v5, 69632, v5
    ds_read2_b32 v[28:29], v5 offset0:0 offset1:1
    v_mul_u32_u24 v5, 6, v19
    v_and_b32 v5, -4, v5
    v_add_u32 v5, 69632, v5
    ds_read2_b32 v[38:39], v5 offset0:0 offset1:1
    s_mov_b32 s26, 5033
    s_mov_b32 s27, 853362
    v_mov_b32 v7, 1
    v_mov_b32 v8, 65000
    v_mov_b32 v9, 0x10000
    s_waitcnt lgkmcnt(8)
    v_and_b32 v70, 1, v10
    v_lshlrev_b32 v70, 4, v70
    v_lshrrev_b64 v[20:21], v70, v[20:21]
    v_and_b32 v71, 1, v15
    v_lshlrev_b32 v71, 4, v71
    v_lshrrev_b64 v[30:31], v71, v[30:31]
    v_lshlrev_b32 v70, 16, v20
    v_and_b32 v71, v6, v20
    v_lshlrev_b32 v72, 16, v30
    v_and_b32 v73, v6, v30
    v_pk_add_f32 v[70:71], v[70:71], v[72:73] neg_lo:[0,1] neg_hi:[0,1]
    v_lshlrev_b32 v72, 16, v21
    v_lshlrev_b32 v73, 16, v31
    v_sub_f32 v72, v72, v73
    v_cvt_pk_bf16_f32 v73, v70, v71
    v_cvt_pk_bf16_f32 v74, v72, v72
    v_lshlrev_b32 v70, 16, v73
    v_and_b32 v71, v6, v73
    v_and_b32 v72, v6, v74
    v_pk_mul_f32 v[74:75], v[70:71], v[70:71]
    v_mul_f32 v73, v72, v72
    v_cvt_pk_bf16_f32 v74, v74, v75
    v_cvt_pk_bf16_f32 v73, v73, v73
    v_lshlrev_b32 v75, 16, v74
    v_and_b32 v74, v6, v74
    v_and_b32 v73, v6, v73
    v_add_f32 v74, v75, v74
    v_add_f32 v73, v74, v73
    v_cvt_pk_bf16_f32 v73, v73, v73
    v_and_b32 v73, v6, v73
    v_add_f32 v73, 0x322bcc77, v73
    v_cvt_pk_bf16_f32 v73, v73, v73
    v_and_b32 v73, v6, v73
    v_sqrt_f32 v73, v73
    v_mul_u32_u24 v60, s26, v15
    v_cvt_pk_bf16_f32 v73, v73, v73
    v_and_b32 v73, v6, v73
    v_rcp_f32 v74, v73
    v_lshrrev_b32 v60, 16, v60
    v_pk_mul_f32 v[70:71], v[70:71], v[74:75] op_sel_hi:[1,0]
    v_mul_f32 v72, v72, v74
    v_cvt_pk_bf16_f32 v41, v70, v71
    v_cvt_pk_bf16_f32 v42, v72, 0
    v_cmp_gt_u32 vcc, 0x409d0000, v73
    s_and_b64 s[50:51], s[50:51], vcc
    v_lshrrev_b32 v43, 16, v73
    v_subrev_u32 v43, 0x40a0, v43
    v_lshlrev_b32 v43, 5, v43
    v_mad_u32_u24 v70, v60, s27, v8
    v_lshrrev_b32 v70, 16, v70
    v_sub_u32 v70, v15, v70
    v_lshlrev_b32 v70, v70, v9
    v_or_b32 v42, v70, v42
    v_lshlrev_b32 v40, 4, v10
    v_or_b32 v40, 0x80000000, v40
    v_lshlrev_b32 v71, 2, v60
    s_mov_b64 exec, s[50:51]
    ds_add_rtn_u32 v65, v71, v7
    s_mov_b64 exec, -1
    s_waitcnt lgkmcnt(7)
    v_and_b32 v70, 1, v11
    v_lshlrev_b32 v70, 4, v70
    v_lshrrev_b64 v[22:23], v70, v[22:23]
    v_and_b32 v71, 1, v16
    v_lshlrev_b32 v71, 4, v71
    v_lshrrev_b64 v[32:33], v71, v[32:33]
    v_lshlrev_b32 v70, 16, v22
    v_and_b32 v71, v6, v22
    v_lshlrev_b32 v72, 16, v32
    v_and_b32 v73, v6, v32
    v_pk_add_f32 v[70:71], v[70:71], v[72:73] neg_lo:[0,1] neg_hi:[0,1]
    v_lshlrev_b32 v72, 16, v23
    v_lshlrev_b32 v73, 16, v33
    v_sub_f32 v72, v72, v73
    v_cvt_pk_bf16_f32 v73, v70, v71
    v_cvt_pk_bf16_f32 v74, v72, v72
    v_lshlrev_b32 v70, 16, v73
    v_and_b32 v71, v6, v73
    v_and_b32 v72, v6, v74
    v_pk_mul_f32 v[74:75], v[70:71], v[70:71]
    v_mul_f32 v73, v72, v72
    v_cvt_pk_bf16_f32 v74, v74, v75
    v_cvt_pk_bf16_f32 v73, v73, v73
    v_lshlrev_b32 v75, 16, v74
    v_and_b32 v74, v6, v74
    v_and_b32 v73, v6, v73
    v_add_f32 v74, v75, v74
    v_add_f32 v73, v74, v73
    v_cvt_pk_bf16_f32 v73, v73, v73
    v_and_b32 v73, v6, v73
    v_add_f32 v73, 0x322bcc77, v73
    v_cvt_pk_bf16_f32 v73, v73, v73
    v_and_b32 v73, v6, v73
    v_sqrt_f32 v73, v73
    v_mul_u32_u24 v61, s26, v16
    v_cvt_pk_bf16_f32 v73, v73, v73
    v_and_b32 v73, v6, v73
    v_rcp_f32 v74, v73
    v_lshrrev_b32 v61, 16, v61
    v_pk_mul_f32 v[70:71], v[70:71], v[74:75] op_sel_hi:[1,0]
    v_mul_f32 v72, v72, v74
    v_cvt_pk_bf16_f32 v45, v70, v71
    v_cvt_pk_bf16_f32 v46, v72, 0
    v_cmp_gt_u32 vcc, 0x409d0000, v73
    s_and_b64 s[52:53], s[52:53], vcc
    v_lshrrev_b32 v47, 16, v73
    v_subrev_u32 v47, 0x40a0, v47
    v_lshlrev_b32 v47, 5, v47
    v_mad_u32_u24 v70, v61, s27, v8
    v_lshrrev_b32 v70, 16, v70
    v_sub_u32 v70, v16, v70
    v_lshlrev_b32 v70, v70, v9
    v_or_b32 v46, v70, v46
    v_lshlrev_b32 v44, 4, v11
    v_or_b32 v44, 0x80000000, v44
    v_lshlrev_b32 v71, 2, v61
    s_mov_b64 exec, s[52:53]
    ds_add_rtn_u32 v66, v71, v7
    s_mov_b64 exec, -1
    s_waitcnt lgkmcnt(6)
    v_and_b32 v70, 1, v12
    v_lshlrev_b32 v70, 4, v70
    v_lshrrev_b64 v[24:25], v70, v[24:25]
    v_and_b32 v71, 1, v17
    v_lshlrev_b32 v71, 4, v71
    v_lshrrev_b64 v[34:35], v71, v[34:35]
    v_lshlrev_b32 v70, 16, v24
    v_and_b32 v71, v6, v24
    v_lshlrev_b32 v72, 16, v34
    v_and_b32 v73, v6, v34
    v_pk_add_f32 v[70:71], v[70:71], v[72:73] neg_lo:[0,1] neg_hi:[0,1]
    v_lshlrev_b32 v72, 16, v25
    v_lshlrev_b32 v73, 16, v35
    v_sub_f32 v72, v72, v73
    v_cvt_pk_bf16_f32 v73, v70, v71
    v_cvt_pk_bf16_f32 v74, v72, v72
    v_lshlrev_b32 v70, 16, v73
    v_and_b32 v71, v6, v73
    v_and_b32 v72, v6, v74
    v_pk_mul_f32 v[74:75], v[70:71], v[70:71]
    v_mul_f32 v73, v72, v72
    v_cvt_pk_bf16_f32 v74, v74, v75
    v_cvt_pk_bf16_f32 v73, v73, v73
    v_lshlrev_b32 v75, 16, v74
    v_and_b32 v74, v6, v74
    v_and_b32 v73, v6, v73
    v_add_f32 v74, v75, v74
    v_add_f32 v73, v74, v73
    v_cvt_pk_bf16_f32 v73, v73, v73
    v_and_b32 v73, v6, v73
    v_add_f32 v73, 0x322bcc77, v73
    v_cvt_pk_bf16_f32 v73, v73, v73
    v_and_b32 v73, v6, v73
    v_sqrt_f32 v73, v73
    v_mul_u32_u24 v62, s26, v17
    v_cvt_pk_bf16_f32 v73, v73, v73
    v_and_b32 v73, v6, v73
    v_rcp_f32 v74, v73
    v_lshrrev_b32 v62, 16, v62
    v_pk_mul_f32 v[70:71], v[70:71], v[74:75] op_sel_hi:[1,0]
    v_mul_f32 v72, v72, v74
    v_cvt_pk_bf16_f32 v49, v70, v71
    v_cvt_pk_bf16_f32 v50, v72, 0
    v_cmp_gt_u32 vcc, 0x409d0000, v73
    s_and_b64 s[54:55], s[54:55], vcc
    v_lshrrev_b32 v51, 16, v73
    v_subrev_u32 v51, 0x40a0, v51
    v_lshlrev_b32 v51, 5, v51
    v_mad_u32_u24 v70, v62, s27, v8
    v_lshrrev_b32 v70, 16, v70
    v_sub_u32 v70, v17, v70
    v_lshlrev_b32 v70, v70, v9
    v_or_b32 v50, v70, v50
    v_lshlrev_b32 v48, 4, v12
    v_or_b32 v48, 0x80000000, v48
    v_lshlrev_b32 v71, 2, v62
    s_mov_b64 exec, s[54:55]
    ds_add_rtn_u32 v67, v71, v7
    s_mov_b64 exec, -1
    s_waitcnt lgkmcnt(5)
    v_and_b32 v70, 1, v13
    v_lshlrev_b32 v70, 4, v70
    v_lshrrev_b64 v[26:27], v70, v[26:27]
    v_and_b32 v71, 1, v18
    v_lshlrev_b32 v71, 4, v71
    v_lshrrev_b64 v[36:37], v71, v[36:37]
    v_lshlrev_b32 v70, 16, v26
    v_and_b32 v71, v6, v26
    v_lshlrev_b32 v72, 16, v36
    v_and_b32 v73, v6, v36
    v_pk_add_f32 v[70:71], v[70:71], v[72:73] neg_lo:[0,1] neg_hi:[0,1]
    v_lshlrev_b32 v72, 16, v27
    v_lshlrev_b32 v73, 16, v37
    v_sub_f32 v72, v72, v73
    v_cvt_pk_bf16_f32 v73, v70, v71
    v_cvt_pk_bf16_f32 v74, v72, v72
    v_lshlrev_b32 v70, 16, v73
    v_and_b32 v71, v6, v73
    v_and_b32 v72, v6, v74
    v_pk_mul_f32 v[74:75], v[70:71], v[70:71]
    v_mul_f32 v73, v72, v72
    v_cvt_pk_bf16_f32 v74, v74, v75
    v_cvt_pk_bf16_f32 v73, v73, v73
    v_lshlrev_b32 v75, 16, v74
    v_and_b32 v74, v6, v74
    v_and_b32 v73, v6, v73
    v_add_f32 v74, v75, v74
    v_add_f32 v73, v74, v73
    v_cvt_pk_bf16_f32 v73, v73, v73
    v_and_b32 v73, v6, v73
    v_add_f32 v73, 0x322bcc77, v73
    v_cvt_pk_bf16_f32 v73, v73, v73
    v_and_b32 v73, v6, v73
    v_sqrt_f32 v73, v73
    v_mul_u32_u24 v63, s26, v18
    v_cvt_pk_bf16_f32 v73, v73, v73
    v_and_b32 v73, v6, v73
    v_rcp_f32 v74, v73
    v_lshrrev_b32 v63, 16, v63
    v_pk_mul_f32 v[70:71], v[70:71], v[74:75] op_sel_hi:[1,0]
    v_mul_f32 v72, v72, v74
    v_cvt_pk_bf16_f32 v53, v70, v71
    v_cvt_pk_bf16_f32 v54, v72, 0
    v_cmp_gt_u32 vcc, 0x409d0000, v73
    s_and_b64 s[56:57], s[56:57], vcc
    v_lshrrev_b32 v55, 16, v73
    v_subrev_u32 v55, 0x40a0, v55
    v_lshlrev_b32 v55, 5, v55
    v_mad_u32_u24 v70, v63, s27, v8
    v_lshrrev_b32 v70, 16, v70
    v_sub_u32 v70, v18, v70
    v_lshlrev_b32 v70, v70, v9
    v_or_b32 v54, v70, v54
    v_lshlrev_b32 v52, 4, v13
    v_or_b32 v52, 0x80000000, v52
    v_lshlrev_b32 v71, 2, v63
    s_mov_b64 exec, s[56:57]
    ds_add_rtn_u32 v68, v71, v7
    s_mov_b64 exec, -1
    s_waitcnt lgkmcnt(4)
    v_and_b32 v70, 1, v14
    v_lshlrev_b32 v70, 4, v70
    v_lshrrev_b64 v[28:29], v70, v[28:29]
    v_and_b32 v71, 1, v19
    v_lshlrev_b32 v71, 4, v71
    v_lshrrev_b64 v[38:39], v71, v[38:39]
    v_lshlrev_b32 v70, 16, v28
    v_and_b32 v71, v6, v28
    v_lshlrev_b32 v72, 16, v38
    v_and_b32 v73, v6, v38
    v_pk_add_f32 v[70:71], v[70:71], v[72:73] neg_lo:[0,1] neg_hi:[0,1]
    v_lshlrev_b32 v72, 16, v29
    v_lshlrev_b32 v73, 16, v39
    v_sub_f32 v72, v72, v73
    v_cvt_pk_bf16_f32 v73, v70, v71
    v_cvt_pk_bf16_f32 v74, v72, v72
    v_lshlrev_b32 v70, 16, v73
    v_and_b32 v71, v6, v73
    v_and_b32 v72, v6, v74
    v_pk_mul_f32 v[74:75], v[70:71], v[70:71]
    v_mul_f32 v73, v72, v72
    v_cvt_pk_bf16_f32 v74, v74, v75
    v_cvt_pk_bf16_f32 v73, v73, v73
    v_lshlrev_b32 v75, 16, v74
    v_and_b32 v74, v6, v74
    v_and_b32 v73, v6, v73
    v_add_f32 v74, v75, v74
    v_add_f32 v73, v74, v73
    v_cvt_pk_bf16_f32 v73, v73, v73
    v_and_b32 v73, v6, v73
    v_add_f32 v73, 0x322bcc77, v73
    v_cvt_pk_bf16_f32 v73, v73, v73
    v_and_b32 v73, v6, v73
    v_sqrt_f32 v73, v73
    v_mul_u32_u24 v64, s26, v19
    v_cvt_pk_bf16_f32 v73, v73, v73
    v_and_b32 v73, v6, v73
    v_rcp_f32 v74, v73
    v_lshrrev_b32 v64, 16, v64
    v_pk_mul_f32 v[70:71], v[70:71], v[74:75] op_sel_hi:[1,0]
    v_mul_f32 v72, v72, v74
    v_cvt_pk_bf16_f32 v57, v70, v71
    v_cvt_pk_bf16_f32 v58, v72, 0
    v_cmp_gt_u32 vcc, 0x409d0000, v73
    s_and_b64 s[58:59], s[58:59], vcc
    v_lshrrev_b32 v59, 16, v73
    v_subrev_u32 v59, 0x40a0, v59
    v_lshlrev_b32 v59, 5, v59
    v_mad_u32_u24 v70, v64, s27, v8
    v_lshrrev_b32 v70, 16, v70
    v_sub_u32 v70, v19, v70
    v_lshlrev_b32 v70, v70, v9
    v_or_b32 v58, v70, v58
    v_lshlrev_b32 v56, 4, v14
    v_or_b32 v56, 0x80000000, v56
    v_lshlrev_b32 v71, 2, v64
    s_mov_b64 exec, s[58:59]
    ds_add_rtn_u32 v69, v71, v7
    s_mov_b64 exec, -1
    s_cmp_lg_u32 s3, 0
    s_cbranch_scc1 K1_NLB
    v_mov_b32 v165, 0
    buffer_load_dword v166, v165, s[92:95], 0 offen sc1
K1_NLB:
    s_waitcnt vmcnt(0) lgkmcnt(0)
    s_barrier
    ds_read_b32 v3, v1
    s_waitcnt lgkmcnt(0)
    v_mov_b32 v4, v3
    s_nop 1
    v_add_u32_dpp v4, v4, v4 row_shr:1 row_mask:0xf bank_mask:0xf
    s_nop 1
    v_add_u32_dpp v4, v4, v4 row_shr:2 row_mask:0xf bank_mask:0xf
    s_nop 1
    v_add_u32_dpp v4, v4, v4 row_shr:4 row_mask:0xf bank_mask:0xf
    s_nop 1
    v_add_u32_dpp v4, v4, v4 row_shr:8 row_mask:0xf bank_mask:0xf
    s_nop 1
    v_add_u32_dpp v4, v4, v4 row_bcast:15 row_mask:0xa bank_mask:0xf
    s_nop 1
    v_add_u32_dpp v4, v4, v4 row_bcast:31 row_mask:0xc bank_mask:0xf
    s_nop 1
    v_readlane_b32 s26, v4, 63
    s_lshl_b32 s27, s3, 2
    v_mov_b32 v5, s27
    v_mov_b32 v8, s26
    ds_write_b32 v5, v8 offset:4096
    s_waitcnt lgkmcnt(0)
    s_barrier
    v_lshlrev_b32 v5, 2, v2
    ds_read_b32 v70, v5 offset:4096
    v_sub_u32 v4, v4, v3
    v_cmp_gt_u32 vcc, 12, v2
    s_waitcnt lgkmcnt(0)
    s_nop 0
    v_cndmask_b32 v70, 0, v70, vcc
    s_nop 1
    v_add_u32_dpp v70, v70, v70 row_shr:1 row_mask:0xf bank_mask:0xf
    s_nop 1
    v_add_u32_dpp v70, v70, v70 row_shr:2 row_mask:0xf bank_mask:0xf
    s_nop 1
    v_add_u32_dpp v70, v70, v70 row_shr:4 row_mask:0xf bank_mask:0xf
    s_nop 1
    v_add_u32_dpp v70, v70, v70 row_shr:8 row_mask:0xf bank_mask:0xf
    s_nop 1
    v_readlane_b32 s61, v70, 11
    s_sub_u32 s26, s3, 1
    s_max_i32 s26, s26, 0
    s_nop 3
    v_readlane_b32 s27, v70, s26
    s_cmp_eq_u32 s3, 0
    s_cselect_b32 s27, 0, s27
    v_add_u32 v4, s27, v4
    ds_write_b32 v1, v4 offset:8192
    v_lshl_or_b32 v3, v3, 16, v4
    s_mul_i32 s26, s91, 3072
    buffer_store_dword v3, v1, s[40:43], s26 offen sc1
    s_waitcnt lgkmcnt(0)
    s_barrier
    v_lshlrev_b32 v60, 2, v60
    ds_read_b32 v60, v60 offset:8192
    v_lshlrev_b32 v61, 2, v61
    ds_read_b32 v61, v61 offset:8192
    v_lshlrev_b32 v62, 2, v62
    ds_read_b32 v62, v62 offset:8192
    v_lshlrev_b32 v63, 2, v63
    ds_read_b32 v63, v63 offset:8192
    v_lshlrev_b32 v64, 2, v64
    ds_read_b32 v64, v64 offset:8192
    s_waitcnt lgkmcnt(4)
    v_add_u32 v60, v60, v65
    v_lshlrev_b32 v60, 4, v60
    s_waitcnt lgkmcnt(3)
    v_add_u32 v61, v61, v66
    v_lshlrev_b32 v61, 4, v61
    s_waitcnt lgkmcnt(2)
    v_add_u32 v62, v62, v67
    v_lshlrev_b32 v62, 4, v62
    s_waitcnt lgkmcnt(1)
    v_add_u32 v63, v63, v68
    v_lshlrev_b32 v63, 4, v63
    s_waitcnt lgkmcnt(0)
    v_add_u32 v64, v64, v69
    v_lshlrev_b32 v64, 4, v64
    s_mov_b64 exec, s[50:51]
    ds_write_b128 v60, v[40:43] offset:12288
    s_mov_b64 exec, s[52:53]
    ds_write_b128 v61, v[44:47] offset:12288
    s_mov_b64 exec, s[54:55]
    ds_write_b128 v62, v[48:51] offset:12288
    s_mov_b64 exec, s[56:57]
    ds_write_b128 v63, v[52:55] offset:12288
    s_mov_b64 exec, s[58:59]
    ds_write_b128 v64, v[56:59] offset:12288
    s_mov_b64 exec, -1
    s_waitcnt lgkmcnt(0)
    s_barrier
    v_lshlrev_b32 v5, 4, v0
    ds_read_b128 v[40:43], v5 offset:12288
    ds_read_b128 v[44:47], v5 offset:24576
    ds_read_b128 v[48:51], v5 offset:36864
    ds_read_b128 v[52:55], v5 offset:49152
    ds_read_b128 v[56:59], v5 offset:61440
    s_lshl_b32 s26, s91, 16
    v_add_u32 v6, 0, v0
    v_cmp_gt_u32 vcc, s61, v6
    v_add_u32 v7, 0, v5
    s_waitcnt lgkmcnt(4)
    s_mov_b64 exec, vcc
    buffer_store_dwordx4 v[40:43], v7, s[44:47], s26 offen sc1
    s_mov_b64 exec, -1
    v_add_u32 v6, 768, v0
    v_cmp_gt_u32 vcc, s61, v6
    v_add_u32 v7, 12288, v5
    s_waitcnt lgkmcnt(3)
    s_mov_b64 exec, vcc
    buffer_store_dwordx4 v[44:47], v7, s[44:47], s26 offen sc1
    s_mov_b64 exec, -1
    v_add_u32 v6, 1536, v0
    v_cmp_gt_u32 vcc, s61, v6
    v_add_u32 v7, 24576, v5
    s_waitcnt lgkmcnt(2)
    s_mov_b64 exec, vcc
    buffer_store_dwordx4 v[48:51], v7, s[44:47], s26 offen sc1
    s_mov_b64 exec, -1
    v_add_u32 v6, 2304, v0
    v_cmp_gt_u32 vcc, s61, v6
    v_add_u32 v7, 36864, v5
    s_waitcnt lgkmcnt(1)
    s_mov_b64 exec, vcc
    buffer_store_dwordx4 v[52:55], v7, s[44:47], s26 offen sc1
    s_mov_b64 exec, -1
    v_add_u32 v6, 3072, v0
    v_cmp_gt_u32 vcc, s61, v6
    v_add_u32 v7, 49152, v5
    s_waitcnt lgkmcnt(0)
    s_mov_b64 exec, vcc
    buffer_store_dwordx4 v[56:59], v7, s[44:47], s26 offen sc1
    s_mov_b64 exec, -1
    s_mov_b32 s101, 0
    s_branch K1_DONE
K1_DONE:
    s_waitcnt vmcnt(0) lgkmcnt(0)
    s_barrier
    s_cmp_lg_u32 s3, 0
    s_cbranch_scc1 K2_START
    s_mov_b32 s68, 0x10000
K1_NLOOPD:
    v_readfirstlane_b32 s100, v166
    s_cmp_lg_u32 s100, 0
    s_cbranch_scc1 K1_NOKD
    v_mov_b32 v165, 0
    buffer_load_dword v166, v165, s[92:95], 0 offen sc1
    s_waitcnt vmcnt(0)
    s_sub_u32 s68, s68, 1
    s_cmp_lg_u32 s68, 0
    s_cbranch_scc1 K1_NLOOPD
K1_NOKD:
    s_add_u32 s64, s20, 0xcf0000
    s_addc_u32 s65, s21, 0
    s_mov_b32 s66, 16384
    s_mov_b32 s67, 0x00020000
    v_mbcnt_lo_u32_b32 v164, -1, 0
    v_mbcnt_hi_u32_b32 v164, -1, v164
    v_lshlrev_b32 v164, 11, v164
    s_lshl_b32 s68, s91, 2
    s_add_u32 s68, s68, 0
    v_mov_b32 v163, s100
    s_mov_b64 exec, 0xff
    buffer_store_dword v163, v164, s[64:67], s68 offen sc1
    s_mov_b64 exec, -1
    s_branch K2_START
K1_END:
    s_endpgm
CODE_END:
.section .rodata,"a"
.p2align 6
.amdhsa_kernel gather_scatter__molecular_angular_painn__graph_kernel
  .amdhsa_next_free_vgpr 168
  .amdhsa_next_free_sgpr 102
  .amdhsa_accum_offset 168
  .amdhsa_group_segment_fixed_size 0
  .amdhsa_kernarg_size 88
  .amdhsa_user_sgpr_count 2
  .amdhsa_user_sgpr_kernarg_segment_ptr 1
  .amdhsa_system_sgpr_workgroup_id_x 1
  .amdhsa_float_denorm_mode_32 3
.end_amdhsa_kernel
```
